```python
import torch

def _softmax(x, axis=-1):
    return torch.softmax(x, dim=axis)
def _gelu(x):
    return torch.nn.functional.gelu(x, approximate="tanh")
def _silu(x):
    return torch.nn.functional.silu(x)
def _sigmoid(x):
    return torch.sigmoid(x)
def _layernorm(x, axis=-1, eps=1e-5):
    m = x.mean(dim=axis, keepdim=True)
    v = x.var(dim=axis, keepdim=True, unbiased=False)
    return (x - m) / torch.sqrt(v + eps)
def _scatter_add(tgt, idx, src, axis=0):
    return tgt.clone().index_add_(axis, idx, src)
def _segment_sum(src, seg, n):
    out = torch.zeros((n,) + src.shape[1:], dtype=src.dtype)
    return out.index_add_(0, seg, src)
def _pad(x, pw):
    flat = tuple(v for pair in reversed(pw) for v in pair)
    return torch.nn.functional.pad(x, flat)

kernel_name = 'recurrent_scan__gqa_block_cached__glu_gated_geglu__decode'

def setup_inputs():

    _w = (lambda a: (lambda t: t.to(torch.bfloat16) if t.is_floating_point() else t)(torch.as_tensor(a)))
    def _A_setup():
        B, Sq, D = 1, 1, 512
        Hq, Hkv, Sk, Dh = 32, 8, 65536, 128
        assert Hq % Hkv == 0, (Hq, Hkv)
        return {
            "x": _w((lambda *s: torch.randn(*s, dtype=torch.bfloat16) * 0.4)(B, Sq, D)),
            "k_cache": _w((lambda *s: torch.randn(*s, dtype=torch.bfloat16) * 1.6)(B, Hkv, Sk, Dh)),
            "v_cache": _w((lambda *s: torch.randn(*s, dtype=torch.bfloat16) * 1.6)(B, Hkv, Sk, Dh)),
            "wq": _w((lambda *s: torch.randn(*s, dtype=torch.bfloat16) * 1.6)(D, Hq * Dh) * (D ** -0.5)),
            "wo": _w((lambda *s: torch.randn(*s, dtype=torch.bfloat16) * 1.6)(Hq * Dh, D) * ((Hq * Dh) ** -0.5)),
        }
    _A_in = _A_setup()

    def _B_setup():
        B, S, Dm, Df = 1, 1, 512, 1792
        return {
            "x": _w((lambda *s: torch.randn(*s, dtype=torch.bfloat16) * 0.4)(B, S, Dm)),
            "w_gate": _w((lambda *s: torch.randn(*s, dtype=torch.bfloat16) * 1.6)(Dm, Df) * (Dm ** -0.5)),
            "w_up": _w((lambda *s: torch.randn(*s, dtype=torch.bfloat16) * 1.6)(Dm, Df) * (Dm ** -0.5)),
            "w_down": _w((lambda *s: torch.randn(*s, dtype=torch.bfloat16) * 1.6)(Df, Dm) * (Df ** -0.5)),
        }
    _B_in = _B_setup()

    return {
        "A_x": _A_in["x"],
        "A_k_cache": _A_in["k_cache"],
        "A_v_cache": _A_in["v_cache"],
        "A_wq": _A_in["wq"],
        "A_wo": _A_in["wo"],
        "B_x": _B_in["x"],
        "B_w_gate": _B_in["w_gate"],
        "B_w_up": _B_in["w_up"],
        "B_w_down": _B_in["w_down"],
    }

def reference(A_x, A_k_cache, A_v_cache, A_wq, A_wo, B_x, B_w_gate, B_w_up, B_w_down):
    def _A_ref(x, k_cache, v_cache, wq, wo):
        B, Sq, D = x.shape
        Hq, Dh = 32, 128
        Hkv = k_cache.shape[1]
        rep = Hq // Hkv
        q = (lambda x, *d: x.permute(*d))((x @ wq).reshape(B, Sq, Hq, Dh), 0, 2, 1, 3)
        k = (lambda x, n, axis: torch.repeat_interleave(x, n, dim=axis))(k_cache, rep, axis=1)
        v = (lambda x, n, axis: torch.repeat_interleave(x, n, dim=axis))(v_cache, rep, axis=1)
        scores = torch.einsum("bhqd,bhkd->bhqk", q, k) * (Dh ** -0.5)
        p = _softmax(scores, axis=-1)
        o = torch.einsum("bhqk,bhkd->bhqd", p, v)
        return (lambda x, *d: x.permute(*d))(o, 0, 2, 1, 3).reshape(B, Sq, Hq * Dh) @ wo

    def _B_ref(x, w_gate, w_up, w_down):
        g = torch.einsum("bsd,df->bsf", x, w_gate)
        u = torch.einsum("bsd,df->bsf", x, w_up)
        h = _gelu(g) * u
        return torch.einsum("bsf,fd->bsd", h, w_down)

    x = A_x
    xn = _layernorm(x, axis=-1)
    s = _A_ref(xn, A_k_cache, A_v_cache, A_wq, A_wo)
    g = _silu(_B_ref(xn, B_w_gate, B_w_up, B_w_down))
    return x + s * g
```

```asm
; @launch grid=(256,1,1) block=(512,1,1) lds=155648
.amdgcn_target "amdgcn-amd-amdhsa--gfx950"
.text
.globl recurrent_scan__gqa_block_cached__glu_gated_geglu__decode_kernel
.p2align 8
.type recurrent_scan__gqa_block_cached__glu_gated_geglu__decode_kernel,@function
recurrent_scan__gqa_block_cached__glu_gated_geglu__decode_kernel:
    s_load_dwordx16 s[4:19], s[0:1], 0
    s_load_dwordx8 s[20:27], s[0:1], 64
    s_cmp_ge_u32 s2, 256
    s_cbranch_scc1 L_end
    v_and_b32 v1, 63, v0
    v_lshrrev_b32 v50, 6, v0
    v_mov_b32 v14, 3584
    v_mov_b32 v51, 0
    v_readfirstlane_b32 s29, v50
    v_lshlrev_b32 v52, 2, v1
    v_cmp_gt_u32 vcc, 16, v0
    s_and_saveexec_b64 s[42:43], vcc
    ds_write_b32 v52, v51 offset:3584
    s_mov_b64 exec, s[42:43]
    s_bfe_u32 s30, s2, 0x30003
    s_lshr_b32 s31, s2, 6
    s_lshl_b32 s31, s31, 3
    s_and_b32 s36, s2, 7
    s_or_b32 s31, s31, s36
    v_lshlrev_b32 v3, 4, v1
    v_lshrrev_b32 v50, 4, v1
    v_bfe_u32 v51, v1, 2, 2
    v_and_b32 v52, 3, v1
    v_lshlrev_b32 v2, 6, v50
    v_lshl_add_u32 v2, v51, 8, v2
    v_lshl_add_u32 v2, v52, 4, v2
    s_lshl_b32 s36, s30, 24
    s_lshl_b32 s37, s31, 19
    s_add_u32 s36, s36, s37
    s_lshl_b32 s40, s30, 2
    s_lshr_b32 s41, s31, 3
    s_add_u32 s40, s40, s41
    s_min_u32 s40, s40, 27
    s_and_b32 s39, s31, 7
    s_lshl_b32 s59, s40, 3
    s_add_u32 s59, s59, s39
    s_movk_i32 s42, 0x2000
    s_cmp_eq_u32 s29, 1
    s_cselect_b32 s42, s42, 3584
    v_lshrrev_b32 v53, 3, v1
    v_mul_lo_u32 v54, v53, s42
    v_and_b32 v52, 7, v1
    v_lshl_add_u32 v54, v52, 4, v54
    s_lshl_b32 s43, s42, 3
    s_and_b32 s37, s31, 3
    s_lshl_b32 s37, s37, 20
    s_lshl_b32 s38, s30, 10
    s_add_u32 s37, s37, s38
    s_lshr_b32 s38, s31, 2
    s_lshl_b32 s38, s38, 7
    s_add_u32 s37, s37, s38
    s_mul_i32 s38, s39, 64*3584
    s_lshl_b32 s41, s40, 7
    s_add_u32 s38, s38, s41
    s_lshl_b32 s64, s30, 9
    s_bfe_u32 s65, s31, 0x20001
    s_lshl_b32 s65, s65, 7
    s_add_u32 s64, s64, s65
    s_lshr_b32 s65, s31, 3
    s_lshl_b32 s65, s65, 5
    s_add_u32 s64, s64, s65
    s_and_b32 s65, s31, 1
    s_lshl_b32 s65, s65, 1
    s_add_u32 s64, s64, s65
    s_lshl_b32 s64, s64, 10
    s_waitcnt lgkmcnt(0)
    s_barrier
    s_cmp_eq_u32 s29, 1
    s_cbranch_scc1 L_spq
    s_cmp_eq_u32 s29, 2
    s_cbranch_scc1 L_fstart
    s_load_dword s28, s[26:27], 0
    s_cmp_eq_u32 s29, 0
    s_cbranch_scc0 L_notloader
    s_setprio 3
    s_add_u32 s32, s6, s36
    s_addc_u32 s33, s7, 0
    s_add_u32 s34, s8, s36
    s_addc_u32 s35, s9, 0
    s_add_u32 s76, s32, 4096
    s_addc_u32 s77, s33, 0
    s_add_u32 s78, s34, 4096
    s_addc_u32 s79, s35, 0
    s_mov_b32 s70, 0
    s_mov_b32 s71, 24576
    s_add_u32 m0, s71, 0
    s_nop 0
    global_load_lds_dwordx4 v2, s[32:33] offset:0 nt
    global_load_lds_dwordx4 v2, s[32:33] offset:1024 nt
    global_load_lds_dwordx4 v2, s[32:33] offset:2048 nt
    global_load_lds_dwordx4 v2, s[32:33] offset:3072 nt
    s_add_u32 m0, s71, 4096
    s_nop 0
    global_load_lds_dwordx4 v2, s[76:77] offset:0 nt
    global_load_lds_dwordx4 v2, s[76:77] offset:1024 nt
    global_load_lds_dwordx4 v2, s[76:77] offset:2048 nt
    global_load_lds_dwordx4 v2, s[76:77] offset:3072 nt
    s_add_u32 m0, s71, 8192
    s_nop 0
    global_load_lds_dwordx4 v3, s[34:35] offset:0 nt
    global_load_lds_dwordx4 v3, s[34:35] offset:1024 nt
    global_load_lds_dwordx4 v3, s[34:35] offset:2048 nt
    global_load_lds_dwordx4 v3, s[34:35] offset:3072 nt
    s_add_u32 m0, s71, 12288
    s_nop 0
    global_load_lds_dwordx4 v3, s[78:79] offset:0 nt
    global_load_lds_dwordx4 v3, s[78:79] offset:1024 nt
    global_load_lds_dwordx4 v3, s[78:79] offset:2048 nt
    global_load_lds_dwordx4 v3, s[78:79] offset:3072 nt
    s_add_u32 s32, s32, 8192
    s_addc_u32 s33, s33, 0
    s_add_u32 s76, s76, 8192
    s_addc_u32 s77, s77, 0
    s_add_u32 s34, s34, 8192
    s_addc_u32 s35, s35, 0
    s_add_u32 s78, s78, 8192
    s_addc_u32 s79, s79, 0
    s_mov_b32 s70, 1
    s_lshl_b32 s80, s30, 24
    s_add_u32 s82, s6, s80
    s_addc_u32 s83, s7, 0
    s_add_u32 s84, s8, s80
    s_addc_u32 s85, s9, 0
    s_lshl_b32 s80, s30, 10
    s_add_u32 s80, s80, 8192
    s_add_u32 s86, s26, s80
    s_addc_u32 s87, s27, 0
L_ld_loopb:
    s_and_b32 s73, s70, 7
    s_lshl_b32 s71, s73, 14
    s_add_u32 s71, s71, 24576
    s_cmp_lt_u32 s70, 8
    s_cbranch_scc1 L_ld_freeb
    s_lshl_b32 s73, s73, 2
    s_add_u32 s73, s73, 3600
    v_mov_b32 v51, s73
    s_sub_u32 s74, s70, 7
    s_mov_b32 s45, 1000000
L_ld_waitb:
    ds_read_b32 v52, v51
    s_waitcnt lgkmcnt(0)
    v_cmp_eq_u32 vcc, s74, v52
    s_cbranch_vccnz L_ld_freeb
    s_waitcnt vmcnt(0)
    s_lshl_b32 s72, s70, 1
    v_mov_b32 v50, s72
    ds_max_u32 v14, v50
    s_sleep 1
    s_sub_u32 s45, s45, 1
    s_cmp_lg_u32 s45, 0
    s_cbranch_scc1 L_ld_waitb
L_ld_freeb:
    s_add_u32 m0, s71, 0
    s_nop 0
    global_load_lds_dwordx4 v2, s[32:33] offset:0 nt
    s_waitcnt vmcnt(20)
    global_load_lds_dwordx4 v2, s[32:33] offset:1024 nt
    s_waitcnt vmcnt(20)
    global_load_lds_dwordx4 v2, s[32:33] offset:2048 nt
    s_waitcnt vmcnt(20)
    global_load_lds_dwordx4 v2, s[32:33] offset:3072 nt
    s_waitcnt vmcnt(20)
    s_lshl_b32 s72, s70, 1
    s_sub_u32 s72, s72, 2
    s_max_i32 s72, s72, 0
    v_mov_b32 v50, s72
    ds_max_u32 v14, v50
    s_add_u32 m0, s71, 4096
    s_nop 0
    global_load_lds_dwordx4 v2, s[76:77] offset:0 nt
    s_waitcnt vmcnt(20)
    global_load_lds_dwordx4 v2, s[76:77] offset:1024 nt
    s_waitcnt vmcnt(20)
    global_load_lds_dwordx4 v2, s[76:77] offset:2048 nt
    s_waitcnt vmcnt(20)
    global_load_lds_dwordx4 v2, s[76:77] offset:3072 nt
    s_waitcnt vmcnt(20)
    s_add_u32 m0, s71, 8192
    s_nop 0
    global_load_lds_dwordx4 v3, s[34:35] offset:0 nt
    s_waitcnt vmcnt(20)
    global_load_lds_dwordx4 v3, s[34:35] offset:1024 nt
    s_waitcnt vmcnt(20)
    global_load_lds_dwordx4 v3, s[34:35] offset:2048 nt
    s_waitcnt vmcnt(20)
    global_load_lds_dwordx4 v3, s[34:35] offset:3072 nt
    s_waitcnt vmcnt(20)
    s_lshl_b32 s72, s70, 1
    s_sub_u32 s72, s72, 1
    s_max_i32 s72, s72, 0
    v_mov_b32 v50, s72
    ds_max_u32 v14, v50
    s_add_u32 m0, s71, 12288
    s_nop 0
    global_load_lds_dwordx4 v3, s[78:79] offset:0 nt
    s_waitcnt vmcnt(20)
    global_load_lds_dwordx4 v3, s[78:79] offset:1024 nt
    s_waitcnt vmcnt(20)
    global_load_lds_dwordx4 v3, s[78:79] offset:2048 nt
    s_waitcnt vmcnt(20)
    global_load_lds_dwordx4 v3, s[78:79] offset:3072 nt
    s_waitcnt vmcnt(20)
    s_add_u32 s32, s32, 8192
    s_addc_u32 s33, s33, 0
    s_add_u32 s76, s76, 8192
    s_addc_u32 s77, s77, 0
    s_add_u32 s34, s34, 8192
    s_addc_u32 s35, s35, 0
    s_add_u32 s78, s78, 8192
    s_addc_u32 s79, s79, 0
    s_add_u32 s70, s70, 1
    s_cmp_lt_u32 s70, 59
    s_cbranch_scc1 L_ld_loopb
    s_mov_b32 s81, 1
    s_atomic_add s81, s[86:87], 0x0 glc
L_dyn:
    s_waitcnt lgkmcnt(0)
    s_cmp_ge_u32 s81, 160
    s_cbranch_scc1 L_dyn_end
    s_and_b32 s80, s81, 31
    s_lshl_b32 s80, s80, 6
    s_lshr_b32 s81, s81, 5
    s_add_u32 s80, s80, s81
    s_add_u32 s80, s80, 59
    s_lshl_b32 s80, s80, 13
    s_add_u32 s32, s82, s80
    s_addc_u32 s33, s83, 0
    s_add_u32 s34, s84, s80
    s_addc_u32 s35, s85, 0
    s_add_u32 s76, s32, 4096
    s_addc_u32 s77, s33, 0
    s_add_u32 s78, s34, 4096
    s_addc_u32 s79, s35, 0
    s_and_b32 s73, s70, 7
    s_lshl_b32 s71, s73, 14
    s_add_u32 s71, s71, 24576
    s_cmp_lt_u32 s70, 8
    s_cbranch_scc1 L_ld_freec
    s_lshl_b32 s73, s73, 2
    s_add_u32 s73, s73, 3600
    v_mov_b32 v51, s73
    s_sub_u32 s74, s70, 7
    s_mov_b32 s45, 1000000
L_ld_waitc:
    ds_read_b32 v52, v51
    s_waitcnt lgkmcnt(0)
    v_cmp_eq_u32 vcc, s74, v52
    s_cbranch_vccnz L_ld_freec
    s_waitcnt vmcnt(0)
    s_lshl_b32 s72, s70, 1
    v_mov_b32 v50, s72
    ds_max_u32 v14, v50
    s_sleep 1
    s_sub_u32 s45, s45, 1
    s_cmp_lg_u32 s45, 0
    s_cbranch_scc1 L_ld_waitc
L_ld_freec:
    s_mov_b32 s81, 1
    s_atomic_add s81, s[86:87], 0x0 glc
    s_add_u32 m0, s71, 0
    s_nop 0
    global_load_lds_dwordx4 v2, s[32:33] offset:0 nt
    s_waitcnt vmcnt(20)
    global_load_lds_dwordx4 v2, s[32:33] offset:1024 nt
    s_waitcnt vmcnt(20)
    global_load_lds_dwordx4 v2, s[32:33] offset:2048 nt
    s_waitcnt vmcnt(20)
    global_load_lds_dwordx4 v2, s[32:33] offset:3072 nt
    s_waitcnt vmcnt(20)
    s_lshl_b32 s72, s70, 1
    s_sub_u32 s72, s72, 2
    s_max_i32 s72, s72, 0
    v_mov_b32 v50, s72
    ds_max_u32 v14, v50
    s_add_u32 m0, s71, 4096
    s_nop 0
    global_load_lds_dwordx4 v2, s[76:77] offset:0 nt
    s_waitcnt vmcnt(20)
    global_load_lds_dwordx4 v2, s[76:77] offset:1024 nt
    s_waitcnt vmcnt(20)
    global_load_lds_dwordx4 v2, s[76:77] offset:2048 nt
    s_waitcnt vmcnt(20)
    global_load_lds_dwordx4 v2, s[76:77] offset:3072 nt
    s_waitcnt vmcnt(20)
    s_add_u32 m0, s71, 8192
    s_nop 0
    global_load_lds_dwordx4 v3, s[34:35] offset:0 nt
    s_waitcnt vmcnt(20)
    global_load_lds_dwordx4 v3, s[34:35] offset:1024 nt
    s_waitcnt vmcnt(20)
    global_load_lds_dwordx4 v3, s[34:35] offset:2048 nt
    s_waitcnt vmcnt(20)
    global_load_lds_dwordx4 v3, s[34:35] offset:3072 nt
    s_waitcnt vmcnt(20)
    s_lshl_b32 s72, s70, 1
    s_sub_u32 s72, s72, 1
    s_max_i32 s72, s72, 0
    v_mov_b32 v50, s72
    ds_max_u32 v14, v50
    s_add_u32 m0, s71, 12288
    s_nop 0
    global_load_lds_dwordx4 v3, s[78:79] offset:0 nt
    s_waitcnt vmcnt(20)
    global_load_lds_dwordx4 v3, s[78:79] offset:1024 nt
    s_waitcnt vmcnt(20)
    global_load_lds_dwordx4 v3, s[78:79] offset:2048 nt
    s_waitcnt vmcnt(20)
    global_load_lds_dwordx4 v3, s[78:79] offset:3072 nt
    s_waitcnt vmcnt(20)
    s_add_u32 s32, s32, 8192
    s_addc_u32 s33, s33, 0
    s_add_u32 s76, s76, 8192
    s_addc_u32 s77, s77, 0
    s_add_u32 s34, s34, 8192
    s_addc_u32 s35, s35, 0
    s_add_u32 s78, s78, 8192
    s_addc_u32 s79, s79, 0
    s_add_u32 s70, s70, 1
    s_branch L_dyn
L_dyn_end:
    v_mov_b32 v50, s70
    ds_write_b32 v14, v50 offset:12
    s_waitcnt vmcnt(16)
    s_lshl_b32 s72, s70, 1
    s_sub_u32 s72, s72, 2
    v_mov_b32 v50, s72
    ds_max_u32 v14, v50
    s_waitcnt vmcnt(8)
    s_lshl_b32 s72, s70, 1
    s_sub_u32 s72, s72, 1
    v_mov_b32 v50, s72
    ds_max_u32 v14, v50
    s_waitcnt vmcnt(0)
    s_lshl_b32 s72, s70, 1
    v_mov_b32 v50, s72
    ds_max_u32 v14, v50
    s_setprio 0
    s_waitcnt lgkmcnt(0)
    s_add_u32 s68, s28, 1
    s_mul_i32 s69, s68, 0x9e3779b1
    s_and_b32 s60, s69, 0xfff
    s_bfe_u32 s61, s69, 0xc000c
    s_mul_i32 s69, s68, 0x85ebca6b
    s_and_b32 s62, s69, 0xfff
    s_bfe_u32 s63, s69, 0xc000c
    s_and_b32 s90, s60, 0xff
    s_and_b32 s91, s61, 0xff
    s_and_b32 s92, s62, 0xff
    s_and_b32 s93, s63, 0xff
    s_branch L_tailsetup
L_notloader:
    s_add_u32 s52, s26, 1835008
    s_addc_u32 s53, s27, 0
L_plain:
    v_and_b32 v50, 3, v1
    v_mov_b32 v51, 0xffff
    v_mov_b32 v55, 0xffff0000
    v_mov_b32 v8, 0
    v_mov_b32 v9, 0
    v_cmp_eq_u32 vcc, 0, v50
    s_nop 1
    v_cndmask_b32 v8, v8, v51, vcc
    v_cmp_eq_u32 vcc, 1, v50
    s_nop 1
    v_cndmask_b32 v8, v8, v55, vcc
    v_cmp_eq_u32 vcc, 2, v50
    s_nop 1
    v_cndmask_b32 v9, v9, v51, vcc
    v_cmp_eq_u32 vcc, 3, v50
    s_nop 1
    v_cndmask_b32 v9, v9, v55, vcc
    v_mov_b32 v10, 0xff800000
    v_mov_b32 v11, 0
    v_mov_b32 v16, 0
    v_mov_b32 v17, 0
    v_mov_b32 v18, 0
    v_mov_b32 v19, 0
    v_mov_b32 v20, 0
    v_mov_b32 v21, 0
    v_mov_b32 v22, 0
    v_mov_b32 v23, 0
    v_mov_b32 v24, 0
    v_mov_b32 v25, 0
    v_mov_b32 v28, 0
    v_mov_b32 v29, 0
    v_mov_b32 v32, 0
    v_mov_b32 v33, 0
    s_mov_b32 s44, 0x3fb8aa3b
    s_mov_b32 s58, 0x3db504f3
    s_waitcnt lgkmcnt(0)
    s_add_u32 s68, s28, 1
    s_mul_i32 s69, s68, 0x9e3779b1
    s_and_b32 s60, s69, 0xfff
    s_bfe_u32 s61, s69, 0xc000c
    s_mul_i32 s69, s68, 0x85ebca6b
    s_and_b32 s62, s69, 0xfff
    s_bfe_u32 s63, s69, 0xc000c
    s_and_b32 s90, s60, 0xff
    s_and_b32 s91, s61, 0xff
    s_and_b32 s92, s62, 0xff
    s_and_b32 s93, s63, 0xff
    s_branch L_cons
L_fstart:
    s_load_dword s28, s[26:27], 0
    global_load_dwordx4 v[56:59], v3, s[4:5]
    s_add_u32 s52, s26, 1835008
    s_addc_u32 s53, s27, 0
    s_waitcnt vmcnt(0) lgkmcnt(0)
    s_add_u32 s68, s28, 1
    s_mul_i32 s69, s68, 0x9e3779b1
    s_and_b32 s60, s69, 0xfff
    s_bfe_u32 s61, s69, 0xc000c
    s_mul_i32 s69, s68, 0x85ebca6b
    s_and_b32 s62, s69, 0xfff
    s_bfe_u32 s63, s69, 0xc000c
    s_and_b32 s90, s60, 0xff
    s_and_b32 s91, s61, 0xff
    s_and_b32 s92, s62, 0xff
    s_and_b32 s93, s63, 0xff
    s_cmp_lt_u32 s30, 7
    s_cbranch_scc0 L_tailsetup
    v_lshlrev_b32 v80, 16, v56
    v_and_b32 v81, 0xffff0000, v56
    v_lshlrev_b32 v82, 16, v57
    v_and_b32 v83, 0xffff0000, v57
    v_lshlrev_b32 v84, 16, v58
    v_and_b32 v85, 0xffff0000, v58
    v_lshlrev_b32 v86, 16, v59
    v_and_b32 v87, 0xffff0000, v59
    v_add_f32 v88, v80, v81
    v_add_f32 v89, v82, v83
    v_add_f32 v90, v84, v85
    v_add_f32 v91, v86, v87
    v_add_f32 v88, v88, v89
    v_add_f32 v90, v90, v91
    v_add_f32 v88, v88, v90
    s_nop 1
    v_add_f32_dpp v88, v88, v88 row_ror:8 row_mask:0xf bank_mask:0xf
    s_nop 1
    v_add_f32_dpp v88, v88, v88 row_ror:4 row_mask:0xf bank_mask:0xf
    s_nop 1
    v_add_f32_dpp v88, v88, v88 row_ror:2 row_mask:0xf bank_mask:0xf
    s_nop 1
    v_add_f32_dpp v88, v88, v88 row_ror:1 row_mask:0xf bank_mask:0xf
    v_mov_b32 v89, v88
    s_nop 1
    v_permlane16_swap_b32 v89, v88
    v_add_f32 v88, v89, v88
    v_mov_b32 v89, v88
    s_nop 1
    v_permlane32_swap_b32 v89, v88
    v_add_f32 v88, v89, v88
    v_mul_f32 v88, 0x3b000000, v88
    v_sub_f32 v64, v80, v88
    v_sub_f32 v65, v81, v88
    v_sub_f32 v66, v82, v88
    v_sub_f32 v67, v83, v88
    v_sub_f32 v68, v84, v88
    v_sub_f32 v69, v85, v88
    v_sub_f32 v70, v86, v88
    v_sub_f32 v71, v87, v88
    v_mul_f32 v90, v64, v64
    v_fmac_f32 v90, v65, v65
    v_fmac_f32 v90, v66, v66
    v_fmac_f32 v90, v67, v67
    v_fmac_f32 v90, v68, v68
    v_fmac_f32 v90, v69, v69
    v_fmac_f32 v90, v70, v70
    v_fmac_f32 v90, v71, v71
    s_nop 1
    v_add_f32_dpp v90, v90, v90 row_ror:8 row_mask:0xf bank_mask:0xf
    s_nop 1
    v_add_f32_dpp v90, v90, v90 row_ror:4 row_mask:0xf bank_mask:0xf
    s_nop 1
    v_add_f32_dpp v90, v90, v90 row_ror:2 row_mask:0xf bank_mask:0xf
    s_nop 1
    v_add_f32_dpp v90, v90, v90 row_ror:1 row_mask:0xf bank_mask:0xf
    v_mov_b32 v89, v90
    s_nop 1
    v_permlane16_swap_b32 v89, v90
    v_add_f32 v90, v89, v90
    v_mov_b32 v89, v90
    s_nop 1
    v_permlane32_swap_b32 v89, v90
    v_add_f32 v90, v89, v90
    v_mul_f32 v90, 0x3b000000, v90
    v_cvt_pk_bf16_f32 v88, v88, v88
    v_and_b32 v88, 0xffff0000, v88
    v_cvt_pk_bf16_f32 v90, v90, v90
    v_and_b32 v90, 0xffff0000, v90
    v_add_f32 v90, 0x3727c5ac, v90
    v_cvt_pk_bf16_f32 v90, v90, v90
    v_and_b32 v90, 0xffff0000, v90
    v_sqrt_f32 v90, v90
    s_nop 0
    v_cvt_pk_bf16_f32 v90, v90, v90
    v_and_b32 v90, 0xffff0000, v90
    v_rcp_f32 v90, v90
    v_sub_f32 v80, v80, v88
    v_sub_f32 v81, v81, v88
    v_sub_f32 v82, v82, v88
    v_sub_f32 v83, v83, v88
    v_sub_f32 v84, v84, v88
    v_sub_f32 v85, v85, v88
    v_sub_f32 v86, v86, v88
    v_sub_f32 v87, v87, v88
    v_cvt_pk_bf16_f32 v80, v80, v80
    v_and_b32 v80, 0xffff0000, v80
    v_cvt_pk_bf16_f32 v81, v81, v81
    v_and_b32 v81, 0xffff0000, v81
    v_cvt_pk_bf16_f32 v82, v82, v82
    v_and_b32 v82, 0xffff0000, v82
    v_cvt_pk_bf16_f32 v83, v83, v83
    v_and_b32 v83, 0xffff0000, v83
    v_cvt_pk_bf16_f32 v84, v84, v84
    v_and_b32 v84, 0xffff0000, v84
    v_cvt_pk_bf16_f32 v85, v85, v85
    v_and_b32 v85, 0xffff0000, v85
    v_cvt_pk_bf16_f32 v86, v86, v86
    v_and_b32 v86, 0xffff0000, v86
    v_cvt_pk_bf16_f32 v87, v87, v87
    v_and_b32 v87, 0xffff0000, v87
    v_mul_f32 v80, v80, v90
    v_mul_f32 v81, v81, v90
    v_mul_f32 v82, v82, v90
    v_mul_f32 v83, v83, v90
    v_mul_f32 v84, v84, v90
    v_mul_f32 v85, v85, v90
    v_mul_f32 v86, v86, v90
    v_mul_f32 v87, v87, v90
    v_cvt_pk_bf16_f32 v80, v80, v80
    v_and_b32 v80, 0xffff0000, v80
    v_cvt_pk_bf16_f32 v81, v81, v81
    v_and_b32 v81, 0xffff0000, v81
    v_cvt_pk_bf16_f32 v82, v82, v82
    v_and_b32 v82, 0xffff0000, v82
    v_cvt_pk_bf16_f32 v83, v83, v83
    v_and_b32 v83, 0xffff0000, v83
    v_cvt_pk_bf16_f32 v84, v84, v84
    v_and_b32 v84, 0xffff0000, v84
    v_cvt_pk_bf16_f32 v85, v85, v85
    v_and_b32 v85, 0xffff0000, v85
    v_cvt_pk_bf16_f32 v86, v86, v86
    v_and_b32 v86, 0xffff0000, v86
    v_cvt_pk_bf16_f32 v87, v87, v87
    v_and_b32 v87, 0xffff0000, v87
    s_sub_u32 s41, s29, 1
    s_lshl_b32 s41, s41, 11
    v_lshlrev_b32 v50, 5, v1
    v_add_u32 v50, s41, v50
    ds_write_b128 v50, v[80:83] offset:4096
    ds_write_b128 v50, v[84:87] offset:4112
    s_and_b32 s42, s31, 3
    s_lshl_b32 s42, s42, 9
    s_lshl_b32 s43, s39, 8
    s_cmp_eq_u32 s29, 1
    s_cselect_b32 s42, s42, s43
    s_cselect_b32 s43, 256, 0
    s_add_u32 s42, s42, s41
    v_lshlrev_b32 v50, 2, v53
    v_add_u32 v50, s42, v50
    v_add_u32 v51, s43, v50
    s_waitcnt lgkmcnt(0)
    ds_read_b32 v96, v50 offset:4096
    ds_read_b32 v97, v50 offset:4128
    ds_read_b32 v98, v50 offset:4160
    ds_read_b32 v99, v50 offset:4192
    ds_read_b32 v100, v50 offset:4224
    ds_read_b32 v101, v50 offset:4256
    ds_read_b32 v102, v50 offset:4288
    ds_read_b32 v103, v50 offset:4320
    ds_read_b32 v104, v51 offset:4096
    ds_read_b32 v105, v51 offset:4128
    ds_read_b32 v106, v51 offset:4160
    ds_read_b32 v107, v51 offset:4192
    ds_read_b32 v108, v51 offset:4224
    ds_read_b32 v109, v51 offset:4256
    ds_read_b32 v110, v51 offset:4288
    ds_read_b32 v111, v51 offset:4320
    v_and_b32 v84, 1, v52
    v_mov_b32 v85, 0xffff
    v_mov_b32 v86, 0xffff0000
    v_cmp_eq_u32 vcc, 1, v84
    v_lshrrev_b32 v84, 1, v52
    s_nop 0
    v_cndmask_b32 v85, v85, v86, vcc
    v_cmp_eq_u32 vcc, 0, v84
    s_nop 1
    v_cndmask_b32 v88, 0, v85, vcc
    v_cmp_eq_u32 vcc, 1, v84
    s_nop 1
    v_cndmask_b32 v89, 0, v85, vcc
    v_cmp_eq_u32 vcc, 2, v84
    s_nop 1
    v_cndmask_b32 v90, 0, v85, vcc
    v_cmp_eq_u32 vcc, 3, v84
    s_nop 1
    v_cndmask_b32 v91, 0, v85, vcc
    s_waitcnt lgkmcnt(0)
    v_cvt_pk_bf16_f32 v96, v96, v96
    v_cvt_pk_bf16_f32 v97, v97, v97
    v_cvt_pk_bf16_f32 v98, v98, v98
    v_cvt_pk_bf16_f32 v99, v99, v99
    v_cvt_pk_bf16_f32 v100, v100, v100
    v_cvt_pk_bf16_f32 v101, v101, v101
    v_cvt_pk_bf16_f32 v102, v102, v102
    v_cvt_pk_bf16_f32 v103, v103, v103
    v_cvt_pk_bf16_f32 v104, v104, v104
    v_cvt_pk_bf16_f32 v105, v105, v105
    v_cvt_pk_bf16_f32 v106, v106, v106
    v_cvt_pk_bf16_f32 v107, v107, v107
    v_cvt_pk_bf16_f32 v108, v108, v108
    v_cvt_pk_bf16_f32 v109, v109, v109
    v_cvt_pk_bf16_f32 v110, v110, v110
    v_cvt_pk_bf16_f32 v111, v111, v111
    v_and_b32 v224, v96, v88
    v_and_b32 v192, v104, v88
    v_and_b32 v225, v96, v89
    v_and_b32 v193, v104, v89
    v_and_b32 v226, v96, v90
    v_and_b32 v194, v104, v90
    v_and_b32 v227, v96, v91
    v_and_b32 v195, v104, v91
    v_and_b32 v228, v97, v88
    v_and_b32 v196, v105, v88
    v_and_b32 v229, v97, v89
    v_and_b32 v197, v105, v89
    v_and_b32 v230, v97, v90
    v_and_b32 v198, v105, v90
    v_and_b32 v231, v97, v91
    v_and_b32 v199, v105, v91
    v_and_b32 v232, v98, v88
    v_and_b32 v200, v106, v88
    v_and_b32 v233, v98, v89
    v_and_b32 v201, v106, v89
    v_and_b32 v234, v98, v90
    v_and_b32 v202, v106, v90
    v_and_b32 v235, v98, v91
    v_and_b32 v203, v106, v91
    v_and_b32 v236, v99, v88
    v_and_b32 v204, v107, v88
    v_and_b32 v237, v99, v89
    v_and_b32 v205, v107, v89
    v_and_b32 v238, v99, v90
    v_and_b32 v206, v107, v90
    v_and_b32 v239, v99, v91
    v_and_b32 v207, v107, v91
    v_and_b32 v240, v100, v88
    v_and_b32 v208, v108, v88
    v_and_b32 v241, v100, v89
    v_and_b32 v209, v108, v89
    v_and_b32 v242, v100, v90
    v_and_b32 v210, v108, v90
    v_and_b32 v243, v100, v91
    v_and_b32 v211, v108, v91
    v_and_b32 v244, v101, v88
    v_and_b32 v212, v109, v88
    v_and_b32 v245, v101, v89
    v_and_b32 v213, v109, v89
    v_and_b32 v246, v101, v90
    v_and_b32 v214, v109, v90
    v_and_b32 v247, v101, v91
    v_and_b32 v215, v109, v91
    v_and_b32 v248, v102, v88
    v_and_b32 v216, v110, v88
    v_and_b32 v249, v102, v89
    v_and_b32 v217, v110, v89
    v_and_b32 v250, v102, v90
    v_and_b32 v218, v110, v90
    v_and_b32 v251, v102, v91
    v_and_b32 v219, v110, v91
    v_and_b32 v252, v103, v88
    v_and_b32 v220, v111, v88
    v_and_b32 v253, v103, v89
    v_and_b32 v221, v111, v89
    v_and_b32 v254, v103, v90
    v_and_b32 v222, v111, v90
    v_and_b32 v255, v103, v91
    v_and_b32 v223, v111, v91
    s_mov_b32 s45, 1000000
L_fdelay:
    ds_read_b128 v[56:59], v14
    s_waitcnt lgkmcnt(0)
    v_cmp_le_u32 vcc, 128, v56
    s_cbranch_vccnz L_sp1
    v_cmp_ne_u32 vcc, 0, v59
    s_cbranch_vccnz L_sp1
    s_sleep 4
    s_sub_u32 s45, s45, 1
    s_cmp_lg_u32 s45, 0
    s_cbranch_scc1 L_fdelay
L_sp1:
    s_add_u32 s46, s16, s38
    s_addc_u32 s47, s17, 0
    s_add_u32 s48, s18, s38
    s_addc_u32 s49, s19, 0
    s_movk_i32 s43, 28672
    global_load_dwordx4 v[128:131], v54, s[46:47]
    global_load_dwordx4 v[132:135], v54, s[48:49]
    s_add_u32 s46, s46, s43
    s_addc_u32 s47, s47, 0
    s_add_u32 s48, s48, s43
    s_addc_u32 s49, s49, 0
    global_load_dwordx4 v[136:139], v54, s[46:47]
    global_load_dwordx4 v[140:143], v54, s[48:49]
    s_add_u32 s46, s46, s43
    s_addc_u32 s47, s47, 0
    s_add_u32 s48, s48, s43
    s_addc_u32 s49, s49, 0
    global_load_dwordx4 v[144:147], v54, s[46:47]
    global_load_dwordx4 v[148:151], v54, s[48:49]
    s_add_u32 s46, s46, s43
    s_addc_u32 s47, s47, 0
    s_add_u32 s48, s48, s43
    s_addc_u32 s49, s49, 0
    global_load_dwordx4 v[152:155], v54, s[46:47]
    global_load_dwordx4 v[156:159], v54, s[48:49]
    s_add_u32 s46, s46, s43
    s_addc_u32 s47, s47, 0
    s_add_u32 s48, s48, s43
    s_addc_u32 s49, s49, 0
    global_load_dwordx4 v[160:163], v54, s[46:47]
    global_load_dwordx4 v[164:167], v54, s[48:49]
    s_add_u32 s46, s46, s43
    s_addc_u32 s47, s47, 0
    s_add_u32 s48, s48, s43
    s_addc_u32 s49, s49, 0
    global_load_dwordx4 v[168:171], v54, s[46:47]
    global_load_dwordx4 v[172:175], v54, s[48:49]
    s_add_u32 s46, s46, s43
    s_addc_u32 s47, s47, 0
    s_add_u32 s48, s48, s43
    s_addc_u32 s49, s49, 0
    global_load_dwordx4 v[176:179], v54, s[46:47]
    global_load_dwordx4 v[180:183], v54, s[48:49]
    s_add_u32 s46, s46, s43
    s_addc_u32 s47, s47, 0
    s_add_u32 s48, s48, s43
    s_addc_u32 s49, s49, 0
    global_load_dwordx4 v[184:187], v54, s[46:47]
    global_load_dwordx4 v[188:191], v54, s[48:49]
    s_branch L_prod
L_spq:
    s_add_u32 s46, s10, s37
    s_addc_u32 s47, s11, 0
    s_add_u32 s48, s46, 0x80000
    s_addc_u32 s49, s47, 0
    s_cmp_eq_u32 s31, 0
    s_cbranch_scc0 L_noctr
    s_lshl_b32 s41, s30, 10
    s_add_u32 s41, s41, 8192
    v_mov_b32 v50, s41
    v_mov_b32 v51, 0
    s_mov_b64 exec, 1
    global_store_dword v50, v51, s[26:27] sc1
    s_mov_b64 exec, -1
L_noctr:
    global_load_dwordx4 v[56:59], v3, s[4:5]
    global_load_dwordx4 v[128:131], v54, s[46:47]
    global_load_dwordx4 v[132:135], v54, s[48:49]
    s_add_u32 s46, s46, s43
    s_addc_u32 s47, s47, 0
    s_add_u32 s48, s48, s43
    s_addc_u32 s49, s49, 0
    global_load_dwordx4 v[136:139], v54, s[46:47]
    global_load_dwordx4 v[140:143], v54, s[48:49]
    s_add_u32 s46, s46, s43
    s_addc_u32 s47, s47, 0
    s_add_u32 s48, s48, s43
    s_addc_u32 s49, s49, 0
    global_load_dwordx4 v[144:147], v54, s[46:47]
    global_load_dwordx4 v[148:151], v54, s[48:49]
    s_add_u32 s46, s46, s43
    s_addc_u32 s47, s47, 0
    s_add_u32 s48, s48, s43
    s_addc_u32 s49, s49, 0
    global_load_dwordx4 v[152:155], v54, s[46:47]
    global_load_dwordx4 v[156:159], v54, s[48:49]
    s_add_u32 s46, s46, s43
    s_addc_u32 s47, s47, 0
    s_add_u32 s48, s48, s43
    s_addc_u32 s49, s49, 0
    global_load_dwordx4 v[160:163], v54, s[46:47]
    global_load_dwordx4 v[164:167], v54, s[48:49]
    s_add_u32 s46, s46, s43
    s_addc_u32 s47, s47, 0
    s_add_u32 s48, s48, s43
    s_addc_u32 s49, s49, 0
    global_load_dwordx4 v[168:171], v54, s[46:47]
    global_load_dwordx4 v[172:175], v54, s[48:49]
    s_add_u32 s46, s46, s43
    s_addc_u32 s47, s47, 0
    s_add_u32 s48, s48, s43
    s_addc_u32 s49, s49, 0
    global_load_dwordx4 v[176:179], v54, s[46:47]
    global_load_dwordx4 v[180:183], v54, s[48:49]
    s_add_u32 s46, s46, s43
    s_addc_u32 s47, s47, 0
    s_add_u32 s48, s48, s43
    s_addc_u32 s49, s49, 0
    global_load_dwordx4 v[184:187], v54, s[46:47]
    global_load_dwordx4 v[188:191], v54, s[48:49]
    s_load_dword s28, s[26:27], 0
    v_and_b32 v50, 3, v1
    v_mov_b32 v51, 0xffff
    v_mov_b32 v55, 0xffff0000
    v_mov_b32 v8, 0
    v_mov_b32 v9, 0
    v_cmp_eq_u32 vcc, 0, v50
    s_nop 1
    v_cndmask_b32 v8, v8, v51, vcc
    v_cmp_eq_u32 vcc, 1, v50
    s_nop 1
    v_cndmask_b32 v8, v8, v55, vcc
    v_cmp_eq_u32 vcc, 2, v50
    s_nop 1
    v_cndmask_b32 v9, v9, v51, vcc
    v_cmp_eq_u32 vcc, 3, v50
    s_nop 1
    v_cndmask_b32 v9, v9, v55, vcc
    v_mov_b32 v10, 0xff800000
    v_mov_b32 v11, 0
    v_mov_b32 v16, 0
    v_mov_b32 v17, 0
    v_mov_b32 v18, 0
    v_mov_b32 v19, 0
    v_mov_b32 v20, 0
    v_mov_b32 v21, 0
    v_mov_b32 v22, 0
    v_mov_b32 v23, 0
    v_mov_b32 v24, 0
    v_mov_b32 v25, 0
    v_mov_b32 v28, 0
    v_mov_b32 v29, 0
    v_mov_b32 v32, 0
    v_mov_b32 v33, 0
    s_mov_b32 s44, 0x3fb8aa3b
    s_mov_b32 s58, 0x3db504f3
    s_waitcnt vmcnt(16) lgkmcnt(0)
    s_add_u32 s68, s28, 1
    s_mul_i32 s69, s68, 0x9e3779b1
    s_and_b32 s60, s69, 0xfff
    s_bfe_u32 s61, s69, 0xc000c
    s_mul_i32 s69, s68, 0x85ebca6b
    s_and_b32 s62, s69, 0xfff
    s_bfe_u32 s63, s69, 0xc000c
    s_and_b32 s90, s60, 0xff
    s_and_b32 s91, s61, 0xff
    s_and_b32 s92, s62, 0xff
    s_and_b32 s93, s63, 0xff
    v_lshlrev_b32 v80, 16, v56
    v_and_b32 v81, 0xffff0000, v56
    v_lshlrev_b32 v82, 16, v57
    v_and_b32 v83, 0xffff0000, v57
    v_lshlrev_b32 v84, 16, v58
    v_and_b32 v85, 0xffff0000, v58
    v_lshlrev_b32 v86, 16, v59
    v_and_b32 v87, 0xffff0000, v59
    v_add_f32 v88, v80, v81
    v_add_f32 v89, v82, v83
    v_add_f32 v90, v84, v85
    v_add_f32 v91, v86, v87
    v_add_f32 v88, v88, v89
    v_add_f32 v90, v90, v91
    v_add_f32 v88, v88, v90
    s_nop 1
    v_add_f32_dpp v88, v88, v88 row_ror:8 row_mask:0xf bank_mask:0xf
    s_nop 1
    v_add_f32_dpp v88, v88, v88 row_ror:4 row_mask:0xf bank_mask:0xf
    s_nop 1
    v_add_f32_dpp v88, v88, v88 row_ror:2 row_mask:0xf bank_mask:0xf
    s_nop 1
    v_add_f32_dpp v88, v88, v88 row_ror:1 row_mask:0xf bank_mask:0xf
    v_mov_b32 v89, v88
    s_nop 1
    v_permlane16_swap_b32 v89, v88
    v_add_f32 v88, v89, v88
    v_mov_b32 v89, v88
    s_nop 1
    v_permlane32_swap_b32 v89, v88
    v_add_f32 v88, v89, v88
    v_mul_f32 v88, 0x3b000000, v88
    v_sub_f32 v64, v80, v88
    v_sub_f32 v65, v81, v88
    v_sub_f32 v66, v82, v88
    v_sub_f32 v67, v83, v88
    v_sub_f32 v68, v84, v88
    v_sub_f32 v69, v85, v88
    v_sub_f32 v70, v86, v88
    v_sub_f32 v71, v87, v88
    v_mul_f32 v90, v64, v64
    v_fmac_f32 v90, v65, v65
    v_fmac_f32 v90, v66, v66
    v_fmac_f32 v90, v67, v67
    v_fmac_f32 v90, v68, v68
    v_fmac_f32 v90, v69, v69
    v_fmac_f32 v90, v70, v70
    v_fmac_f32 v90, v71, v71
    s_nop 1
    v_add_f32_dpp v90, v90, v90 row_ror:8 row_mask:0xf bank_mask:0xf
    s_nop 1
    v_add_f32_dpp v90, v90, v90 row_ror:4 row_mask:0xf bank_mask:0xf
    s_nop 1
    v_add_f32_dpp v90, v90, v90 row_ror:2 row_mask:0xf bank_mask:0xf
    s_nop 1
    v_add_f32_dpp v90, v90, v90 row_ror:1 row_mask:0xf bank_mask:0xf
    v_mov_b32 v89, v90
    s_nop 1
    v_permlane16_swap_b32 v89, v90
    v_add_f32 v90, v89, v90
    v_mov_b32 v89, v90
    s_nop 1
    v_permlane32_swap_b32 v89, v90
    v_add_f32 v90, v89, v90
    v_mul_f32 v90, 0x3b000000, v90
    v_cvt_pk_bf16_f32 v88, v88, v88
    v_and_b32 v88, 0xffff0000, v88
    v_cvt_pk_bf16_f32 v90, v90, v90
    v_and_b32 v90, 0xffff0000, v90
    v_add_f32 v90, 0x3727c5ac, v90
    v_cvt_pk_bf16_f32 v90, v90, v90
    v_and_b32 v90, 0xffff0000, v90
    v_sqrt_f32 v90, v90
    s_nop 0
    v_cvt_pk_bf16_f32 v90, v90, v90
    v_and_b32 v90, 0xffff0000, v90
    v_rcp_f32 v90, v90
    v_sub_f32 v80, v80, v88
    v_sub_f32 v81, v81, v88
    v_sub_f32 v82, v82, v88
    v_sub_f32 v83, v83, v88
    v_sub_f32 v84, v84, v88
    v_sub_f32 v85, v85, v88
    v_sub_f32 v86, v86, v88
    v_sub_f32 v87, v87, v88
    v_cvt_pk_bf16_f32 v80, v80, v80
    v_and_b32 v80, 0xffff0000, v80
    v_cvt_pk_bf16_f32 v81, v81, v81
    v_and_b32 v81, 0xffff0000, v81
    v_cvt_pk_bf16_f32 v82, v82, v82
    v_and_b32 v82, 0xffff0000, v82
    v_cvt_pk_bf16_f32 v83, v83, v83
    v_and_b32 v83, 0xffff0000, v83
    v_cvt_pk_bf16_f32 v84, v84, v84
    v_and_b32 v84, 0xffff0000, v84
    v_cvt_pk_bf16_f32 v85, v85, v85
    v_and_b32 v85, 0xffff0000, v85
    v_cvt_pk_bf16_f32 v86, v86, v86
    v_and_b32 v86, 0xffff0000, v86
    v_cvt_pk_bf16_f32 v87, v87, v87
    v_and_b32 v87, 0xffff0000, v87
    v_mul_f32 v80, v80, v90
    v_mul_f32 v81, v81, v90
    v_mul_f32 v82, v82, v90
    v_mul_f32 v83, v83, v90
    v_mul_f32 v84, v84, v90
    v_mul_f32 v85, v85, v90
    v_mul_f32 v86, v86, v90
    v_mul_f32 v87, v87, v90
    v_cvt_pk_bf16_f32 v80, v80, v80
    v_and_b32 v80, 0xffff0000, v80
    v_cvt_pk_bf16_f32 v81, v81, v81
    v_and_b32 v81, 0xffff0000, v81
    v_cvt_pk_bf16_f32 v82, v82, v82
    v_and_b32 v82, 0xffff0000, v82
    v_cvt_pk_bf16_f32 v83, v83, v83
    v_and_b32 v83, 0xffff0000, v83
    v_cvt_pk_bf16_f32 v84, v84, v84
    v_and_b32 v84, 0xffff0000, v84
    v_cvt_pk_bf16_f32 v85, v85, v85
    v_and_b32 v85, 0xffff0000, v85
    v_cvt_pk_bf16_f32 v86, v86, v86
    v_and_b32 v86, 0xffff0000, v86
    v_cvt_pk_bf16_f32 v87, v87, v87
    v_and_b32 v87, 0xffff0000, v87
    s_sub_u32 s41, s29, 1
    s_lshl_b32 s41, s41, 11
    v_lshlrev_b32 v50, 5, v1
    v_add_u32 v50, s41, v50
    ds_write_b128 v50, v[80:83] offset:4096
    ds_write_b128 v50, v[84:87] offset:4112
    s_and_b32 s42, s31, 3
    s_lshl_b32 s42, s42, 9
    s_lshl_b32 s43, s39, 8
    s_cmp_eq_u32 s29, 1
    s_cselect_b32 s42, s42, s43
    s_cselect_b32 s43, 256, 0
    s_add_u32 s42, s42, s41
    v_lshlrev_b32 v50, 2, v53
    v_add_u32 v50, s42, v50
    v_add_u32 v51, s43, v50
    s_waitcnt lgkmcnt(0)
    ds_read_b32 v96, v50 offset:4096
    ds_read_b32 v97, v50 offset:4128
    ds_read_b32 v98, v50 offset:4160
    ds_read_b32 v99, v50 offset:4192
    ds_read_b32 v100, v50 offset:4224
    ds_read_b32 v101, v50 offset:4256
    ds_read_b32 v102, v50 offset:4288
    ds_read_b32 v103, v50 offset:4320
    ds_read_b32 v104, v51 offset:4096
    ds_read_b32 v105, v51 offset:4128
    ds_read_b32 v106, v51 offset:4160
    ds_read_b32 v107, v51 offset:4192
    ds_read_b32 v108, v51 offset:4224
    ds_read_b32 v109, v51 offset:4256
    ds_read_b32 v110, v51 offset:4288
    ds_read_b32 v111, v51 offset:4320
    v_and_b32 v84, 1, v52
    v_mov_b32 v85, 0xffff
    v_mov_b32 v86, 0xffff0000
    v_cmp_eq_u32 vcc, 1, v84
    v_lshrrev_b32 v84, 1, v52
    s_nop 0
    v_cndmask_b32 v85, v85, v86, vcc
    v_cmp_eq_u32 vcc, 0, v84
    s_nop 1
    v_cndmask_b32 v88, 0, v85, vcc
    v_cmp_eq_u32 vcc, 1, v84
    s_nop 1
    v_cndmask_b32 v89, 0, v85, vcc
    v_cmp_eq_u32 vcc, 2, v84
    s_nop 1
    v_cndmask_b32 v90, 0, v85, vcc
    v_cmp_eq_u32 vcc, 3, v84
    s_nop 1
    v_cndmask_b32 v91, 0, v85, vcc
    s_waitcnt lgkmcnt(0)
    v_cvt_pk_bf16_f32 v96, v96, v96
    v_cvt_pk_bf16_f32 v97, v97, v97
    v_cvt_pk_bf16_f32 v98, v98, v98
    v_cvt_pk_bf16_f32 v99, v99, v99
    v_cvt_pk_bf16_f32 v100, v100, v100
    v_cvt_pk_bf16_f32 v101, v101, v101
    v_cvt_pk_bf16_f32 v102, v102, v102
    v_cvt_pk_bf16_f32 v103, v103, v103
    v_cvt_pk_bf16_f32 v104, v104, v104
    v_cvt_pk_bf16_f32 v105, v105, v105
    v_cvt_pk_bf16_f32 v106, v106, v106
    v_cvt_pk_bf16_f32 v107, v107, v107
    v_cvt_pk_bf16_f32 v108, v108, v108
    v_cvt_pk_bf16_f32 v109, v109, v109
    v_cvt_pk_bf16_f32 v110, v110, v110
    v_cvt_pk_bf16_f32 v111, v111, v111
    v_and_b32 v224, v96, v88
    v_and_b32 v192, v104, v88
    v_and_b32 v225, v96, v89
    v_and_b32 v193, v104, v89
    v_and_b32 v226, v96, v90
    v_and_b32 v194, v104, v90
    v_and_b32 v227, v96, v91
    v_and_b32 v195, v104, v91
    v_and_b32 v228, v97, v88
    v_and_b32 v196, v105, v88
    v_and_b32 v229, v97, v89
    v_and_b32 v197, v105, v89
    v_and_b32 v230, v97, v90
    v_and_b32 v198, v105, v90
    v_and_b32 v231, v97, v91
    v_and_b32 v199, v105, v91
    v_and_b32 v232, v98, v88
    v_and_b32 v200, v106, v88
    v_and_b32 v233, v98, v89
    v_and_b32 v201, v106, v89
    v_and_b32 v234, v98, v90
    v_and_b32 v202, v106, v90
    v_and_b32 v235, v98, v91
    v_and_b32 v203, v106, v91
    v_and_b32 v236, v99, v88
    v_and_b32 v204, v107, v88
    v_and_b32 v237, v99, v89
    v_and_b32 v205, v107, v89
    v_and_b32 v238, v99, v90
    v_and_b32 v206, v107, v90
    v_and_b32 v239, v99, v91
    v_and_b32 v207, v107, v91
    v_and_b32 v240, v100, v88
    v_and_b32 v208, v108, v88
    v_and_b32 v241, v100, v89
    v_and_b32 v209, v108, v89
    v_and_b32 v242, v100, v90
    v_and_b32 v210, v108, v90
    v_and_b32 v243, v100, v91
    v_and_b32 v211, v108, v91
    v_and_b32 v244, v101, v88
    v_and_b32 v212, v109, v88
    v_and_b32 v245, v101, v89
    v_and_b32 v213, v109, v89
    v_and_b32 v246, v101, v90
    v_and_b32 v214, v109, v90
    v_and_b32 v247, v101, v91
    v_and_b32 v215, v109, v91
    v_and_b32 v248, v102, v88
    v_and_b32 v216, v110, v88
    v_and_b32 v249, v102, v89
    v_and_b32 v217, v110, v89
    v_and_b32 v250, v102, v90
    v_and_b32 v218, v110, v90
    v_and_b32 v251, v102, v91
    v_and_b32 v219, v110, v91
    v_and_b32 v252, v103, v88
    v_and_b32 v220, v111, v88
    v_and_b32 v253, v103, v89
    v_and_b32 v221, v111, v89
    v_and_b32 v254, v103, v90
    v_and_b32 v222, v111, v90
    v_and_b32 v255, v103, v91
    v_and_b32 v223, v111, v91
L_prod:
    s_waitcnt vmcnt(14)
    v_mfma_f32_16x16x32_bf16 v[64:67], v[128:131], v[224:227], 0
    v_mfma_f32_16x16x32_bf16 v[68:71], v[132:135], v[192:195], 0
    s_waitcnt vmcnt(12)
    v_mfma_f32_16x16x32_bf16 v[64:67], v[136:139], v[228:231], v[64:67]
    v_mfma_f32_16x16x32_bf16 v[68:71], v[140:143], v[196:199], v[68:71]
    s_waitcnt vmcnt(10)
    v_mfma_f32_16x16x32_bf16 v[64:67], v[144:147], v[232:235], v[64:67]
    v_mfma_f32_16x16x32_bf16 v[68:71], v[148:151], v[200:203], v[68:71]
    s_waitcnt vmcnt(8)
    v_mfma_f32_16x16x32_bf16 v[64:67], v[152:155], v[236:239], v[64:67]
    v_mfma_f32_16x16x32_bf16 v[68:71], v[156:159], v[204:207], v[68:71]
    s_waitcnt vmcnt(6)
    v_mfma_f32_16x16x32_bf16 v[64:67], v[160:163], v[240:243], v[64:67]
    v_mfma_f32_16x16x32_bf16 v[68:71], v[164:167], v[208:211], v[68:71]
    s_waitcnt vmcnt(4)
    v_mfma_f32_16x16x32_bf16 v[64:67], v[168:171], v[244:247], v[64:67]
    v_mfma_f32_16x16x32_bf16 v[68:71], v[172:175], v[212:215], v[68:71]
    s_waitcnt vmcnt(2)
    v_mfma_f32_16x16x32_bf16 v[64:67], v[176:179], v[248:251], v[64:67]
    v_mfma_f32_16x16x32_bf16 v[68:71], v[180:183], v[216:219], v[68:71]
    s_waitcnt vmcnt(0)
    v_mfma_f32_16x16x32_bf16 v[64:67], v[184:187], v[252:255], v[64:67]
    v_mfma_f32_16x16x32_bf16 v[68:71], v[188:191], v[220:223], v[68:71]
    v_lshrrev_b32 v50, 4, v1
    v_lshlrev_b32 v50, 7, v50
    v_lshl_add_u32 v50, v52, 2, v50
    s_sub_u32 s41, s29, 1
    s_lshl_b32 s41, s41, 9
    v_add_u32 v50, s41, v50
    v_bfe_u32 v56, v1, 4, 1
    v_and_b32 v51, 15, v1
    v_lshlrev_b32 v52, 4, v51
    v_add_u32 v52, s41, v52
    v_mov_b32_dpp v72, v64 row_ror:8 row_mask:0xf bank_mask:0xf
    v_mov_b32_dpp v73, v65 row_ror:8 row_mask:0xf bank_mask:0xf
    v_mov_b32_dpp v74, v66 row_ror:8 row_mask:0xf bank_mask:0xf
    v_mov_b32_dpp v75, v67 row_ror:8 row_mask:0xf bank_mask:0xf
    v_mov_b32_dpp v76, v68 row_ror:8 row_mask:0xf bank_mask:0xf
    v_mov_b32_dpp v77, v69 row_ror:8 row_mask:0xf bank_mask:0xf
    v_mov_b32_dpp v78, v70 row_ror:8 row_mask:0xf bank_mask:0xf
    v_mov_b32_dpp v79, v71 row_ror:8 row_mask:0xf bank_mask:0xf
    v_mov_b32 v80, v72
    v_mov_b32 v81, v73
    v_mov_b32 v82, v74
    v_mov_b32 v83, v75
    v_mov_b32 v84, v76
    v_mov_b32 v85, v77
    v_mov_b32 v86, v78
    v_mov_b32 v87, v79
    s_nop 1
    v_permlane32_swap_b32 v80, v72
    v_permlane32_swap_b32 v81, v73
    v_permlane32_swap_b32 v82, v74
    v_permlane32_swap_b32 v83, v75
    v_permlane32_swap_b32 v84, v76
    v_permlane32_swap_b32 v85, v77
    v_permlane32_swap_b32 v86, v78
    v_permlane32_swap_b32 v87, v79
    v_add_f32 v64, v64, v72
    v_add_f32 v65, v65, v73
    v_add_f32 v66, v66, v74
    v_add_f32 v67, v67, v75
    v_add_f32 v68, v68, v76
    v_add_f32 v69, v69, v77
    v_add_f32 v70, v70, v78
    v_add_f32 v71, v71, v79
    v_lshl_add_u32 v53, v56, 8, v52
    s_mov_b32 exec_lo, 0x00ff00ff
    s_mov_b32 exec_hi, 0
    ds_write_b32 v50, v64 offset:0
    ds_write_b32 v50, v65 offset:32
    ds_write_b32 v50, v66 offset:64
    ds_write_b32 v50, v67 offset:96
    ds_write_b32 v50, v68 offset:256
    ds_write_b32 v50, v69 offset:288
    ds_write_b32 v50, v70 offset:320
    ds_write_b32 v50, v71 offset:352
    s_mov_b64 exec, -1
    v_mov_b32 v50, v56
    s_waitcnt lgkmcnt(0)
    ds_read_b128 v[64:67], v53 offset:0
    ds_read_b128 v[68:71], v52 offset:256
    s_lshl_b32 s41, s30, 13
    s_and_b32 s42, s31, 3
    s_lshl_b32 s42, s42, 11
    s_add_u32 s41, s41, s42
    s_lshr_b32 s42, s31, 2
    s_lshl_b32 s42, s42, 8
    s_add_u32 s41, s41, s42
    s_add_u32 s41, s41, 1114112
    s_lshl_b32 s42, s40, 12
    s_lshl_b32 s43, s39, 9
    s_add_u32 s42, s42, s43
    s_add_u32 s42, s42, 1179648
    s_cmp_eq_u32 s29, 1
    s_cselect_b32 s41, s41, s42
    v_lshlrev_b32 v53, 8, v50
    v_lshl_add_u32 v53, v51, 4, v53
    v_add_u32 v53, s41, v53
    v_mov_b32 v55, 0xffffff00
    s_waitcnt lgkmcnt(0)
    s_cbranch_scc0 L_noaddB
    v_add_f32 v64, v64, v68
    v_add_f32 v65, v65, v69
    v_add_f32 v66, v66, v70
    v_add_f32 v67, v67, v71
L_noaddB:
    v_and_or_b32 v64, v64, v55, s90
    v_and_or_b32 v65, v65, v55, s91
    v_and_or_b32 v66, v66, v55, s92
    v_and_or_b32 v67, v67, v55, s93
    s_mov_b32 exec_hi, 0
    s_mov_b32 exec_lo, 0xffff
    s_cbranch_scc1 L_pub
    s_mov_b32 exec_lo, -1
    s_cmp_lt_u32 s30, 7
    s_cbranch_scc1 L_pub
    s_mov_b64 exec, -1
    s_branch L_w1b
L_pub:
    global_store_dwordx4 v53, v[64:67], s[26:27] sc1
    s_mov_b64 exec, -1
    s_cmp_eq_u32 s29, 1
    s_cbranch_scc1 L_w0
L_w1b:
    s_branch L_ffn2
L_w0:
    v_bfe_u32 v80, v1, 2, 2
    v_lshlrev_b32 v80, 9, v80
    v_lshrrev_b32 v81, 4, v1
    v_lshl_add_u32 v80, v81, 7, v80
    v_and_b32 v81, 3, v1
    v_lshl_add_u32 v80, v81, 5, v80
    s_lshl_b32 s41, s30, 13
    s_add_u32 s41, s41, 1118208
    v_add_u32 v55, s41, v80
    s_sleep 16
    s_sleep 16
    s_mov_b32 s45, 200000
L_qpoll:
    global_load_dwordx4 v[64:67], v55, s[26:27] offset:-4096 sc1
    global_load_dwordx4 v[68:71], v55, s[26:27] offset:-4080 sc1
    global_load_dwordx4 v[72:75], v55, s[26:27] offset:-2048 sc1
    global_load_dwordx4 v[76:79], v55, s[26:27] offset:-2032 sc1
    global_load_dwordx4 v[80:83], v55, s[26:27] offset:0 sc1
    global_load_dwordx4 v[84:87], v55, s[26:27] offset:16 sc1
    global_load_dwordx4 v[88:91], v55, s[26:27] offset:2048 sc1
    global_load_dwordx4 v[92:95], v55, s[26:27] offset:2064 sc1
    s_waitcnt vmcnt(0)
    v_xor_b32 v64, s90, v64
    v_xor_b32 v65, s91, v65
    v_xor_b32 v66, s92, v66
    v_xor_b32 v67, s93, v67
    v_xor_b32 v68, s90, v68
    v_xor_b32 v69, s91, v69
    v_xor_b32 v70, s92, v70
    v_xor_b32 v71, s93, v71
    v_xor_b32 v72, s90, v72
    v_xor_b32 v73, s91, v73
    v_xor_b32 v74, s92, v74
    v_xor_b32 v75, s93, v75
    v_xor_b32 v76, s90, v76
    v_xor_b32 v77, s91, v77
    v_xor_b32 v78, s92, v78
    v_xor_b32 v79, s93, v79
    v_xor_b32 v80, s90, v80
    v_xor_b32 v81, s91, v81
    v_xor_b32 v82, s92, v82
    v_xor_b32 v83, s93, v83
    v_xor_b32 v84, s90, v84
    v_xor_b32 v85, s91, v85
    v_xor_b32 v86, s92, v86
    v_xor_b32 v87, s93, v87
    v_xor_b32 v88, s90, v88
    v_xor_b32 v89, s91, v89
    v_xor_b32 v90, s92, v90
    v_xor_b32 v91, s93, v91
    v_xor_b32 v92, s90, v92
    v_xor_b32 v93, s91, v93
    v_xor_b32 v94, s92, v94
    v_xor_b32 v95, s93, v95
    v_or3_b32 v50, v64, v65, v66
    v_or3_b32 v50, v50, v67, v68
    v_or3_b32 v50, v50, v69, v70
    v_or3_b32 v50, v50, v71, v72
    v_or3_b32 v50, v50, v73, v74
    v_or3_b32 v50, v50, v75, v76
    v_or3_b32 v50, v50, v77, v78
    v_or3_b32 v50, v50, v79, v80
    v_or3_b32 v50, v50, v81, v82
    v_or3_b32 v50, v50, v83, v84
    v_or3_b32 v50, v50, v85, v86
    v_or3_b32 v50, v50, v87, v88
    v_or3_b32 v50, v50, v89, v90
    v_or3_b32 v50, v50, v91, v92
    v_or3_b32 v50, v50, v93, v94
    v_or_b32 v50, v50, v95
    v_and_b32 v50, 0xff, v50
    v_cmp_ne_u32 vcc, 0, v50
    s_cbranch_vccz L_qgot
    s_sleep 1
    s_sub_u32 s45, s45, 1
    s_cmp_lg_u32 s45, 0
    s_cbranch_scc1 L_qpoll
L_qgot:
    v_add_f32 v64, v64, v72
    v_add_f32 v65, v65, v73
    v_add_f32 v66, v66, v74
    v_add_f32 v67, v67, v75
    v_add_f32 v68, v68, v76
    v_add_f32 v69, v69, v77
    v_add_f32 v70, v70, v78
    v_add_f32 v71, v71, v79
    v_add_f32 v64, v64, v80
    v_add_f32 v65, v65, v81
    v_add_f32 v66, v66, v82
    v_add_f32 v67, v67, v83
    v_add_f32 v68, v68, v84
    v_add_f32 v69, v69, v85
    v_add_f32 v70, v70, v86
    v_add_f32 v71, v71, v87
    v_add_f32 v64, v64, v88
    v_add_f32 v65, v65, v89
    v_add_f32 v66, v66, v90
    v_add_f32 v67, v67, v91
    v_add_f32 v68, v68, v92
    v_add_f32 v69, v69, v93
    v_add_f32 v70, v70, v94
    v_add_f32 v71, v71, v95
    v_cvt_pk_bf16_f32 v72, v64, v65
    v_cvt_pk_bf16_f32 v73, v66, v67
    v_cvt_pk_bf16_f32 v74, v68, v69
    v_cvt_pk_bf16_f32 v75, v70, v71
    ds_write_b128 v3, v[72:75] offset:1024
    v_mov_b32 v51, 1
    s_waitcnt lgkmcnt(0)
    ds_write_b32 v14, v51 offset:8
    s_branch L_cons
L_ffn2:
    v_and_b32 v50, 31, v1
    v_lshrrev_b32 v51, 2, v50
    v_lshlrev_b32 v51, 9, v51
    v_bfe_u32 v52, v50, 1, 1
    v_lshl_add_u32 v51, v52, 8, v51
    v_and_b32 v52, 1, v50
    v_lshl_add_u32 v51, v52, 4, v51
    s_lshl_b32 s41, s40, 12
    s_lshl_b32 s42, s39, 5
    s_add_u32 s41, s41, s42
    s_add_u32 s41, s41, 1179648
    v_add_u32 v51, s41, v51
    s_mov_b32 s45, 1000000
L_fwait2:
    ds_read_b128 v[56:59], v14
    s_waitcnt lgkmcnt(0)
    v_lshlrev_b32 v59, 1, v59
    v_add_u32 v59, -1, v59
    v_cmp_gt_u32 vcc, v56, v59
    s_cbranch_vccnz L_fwait2_done
    s_sleep 2
    s_sub_u32 s45, s45, 1
    s_cmp_lg_u32 s45, 0
    s_cbranch_scc1 L_fwait2
L_fwait2_done:
    s_lshl_b32 s43, s59, 13
    s_add_u32 s43, s43, 4096
    s_add_u32 s46, s20, s43
    s_addc_u32 s47, s21, 0
    v_lshlrev_b32 v50, 3, v1
    global_load_dwordx2 v[192:193], v50, s[46:47] offset:-4096
    global_load_dwordx2 v[194:195], v50, s[46:47] offset:-3584
    global_load_dwordx2 v[196:197], v50, s[46:47] offset:-3072
    global_load_dwordx2 v[198:199], v50, s[46:47] offset:-2560
    global_load_dwordx2 v[200:201], v50, s[46:47] offset:-2048
    global_load_dwordx2 v[202:203], v50, s[46:47] offset:-1536
    global_load_dwordx2 v[204:205], v50, s[46:47] offset:-1024
    global_load_dwordx2 v[206:207], v50, s[46:47] offset:-512
    global_load_dwordx2 v[208:209], v50, s[46:47] offset:0
    global_load_dwordx2 v[210:211], v50, s[46:47] offset:512
    global_load_dwordx2 v[212:213], v50, s[46:47] offset:1024
    global_load_dwordx2 v[214:215], v50, s[46:47] offset:1536
    global_load_dwordx2 v[216:217], v50, s[46:47] offset:2048
    global_load_dwordx2 v[218:219], v50, s[46:47] offset:2560
    global_load_dwordx2 v[220:221], v50, s[46:47] offset:3072
    global_load_dwordx2 v[222:223], v50, s[46:47] offset:3584
    s_mov_b32 s45, 200000
L_fpoll:
    global_load_dwordx4 v[64:67], v51, s[26:27] sc1
    s_waitcnt vmcnt(0)
    v_xor_b32 v64, s90, v64
    v_xor_b32 v65, s91, v65
    v_xor_b32 v66, s92, v66
    v_xor_b32 v67, s93, v67
    v_or3_b32 v50, v64, v65, v66
    v_or_b32 v50, v50, v67
    v_and_b32 v50, 0xff, v50
    v_cmp_ne_u32 vcc, 0, v50
    s_cbranch_vccz L_fgot
    s_sleep 1
    s_sub_u32 s45, s45, 1
    s_cmp_lg_u32 s45, 0
    s_cbranch_scc1 L_fpoll
L_fgot:
    v_add_f32_dpp v64, v64, v64 row_ror:4 row_mask:0xf bank_mask:0xf
    v_add_f32_dpp v65, v65, v65 row_ror:4 row_mask:0xf bank_mask:0xf
    v_add_f32_dpp v66, v66, v66 row_ror:4 row_mask:0xf bank_mask:0xf
    v_add_f32_dpp v67, v67, v67 row_ror:4 row_mask:0xf bank_mask:0xf
    v_add_f32_dpp v64, v64, v64 row_ror:8 row_mask:0xf bank_mask:0xf
    v_add_f32_dpp v65, v65, v65 row_ror:8 row_mask:0xf bank_mask:0xf
    v_add_f32_dpp v66, v66, v66 row_ror:8 row_mask:0xf bank_mask:0xf
    v_add_f32_dpp v67, v67, v67 row_ror:8 row_mask:0xf bank_mask:0xf
    v_mov_b32 v68, v64
    v_mov_b32 v69, v65
    v_mov_b32 v70, v66
    v_mov_b32 v71, v67
    s_nop 0
    v_permlane16_swap_b32 v68, v64
    v_permlane16_swap_b32 v69, v65
    v_permlane16_swap_b32 v70, v66
    v_permlane16_swap_b32 v71, v67
    v_add_f32 v64, v64, v68
    v_add_f32 v65, v65, v69
    v_add_f32 v66, v66, v70
    v_add_f32 v67, v67, v71
    s_nop 0
    v_mov_b32_dpp v68, v64 row_shl:2 row_mask:0xf bank_mask:0xf
    v_mov_b32_dpp v69, v65 row_shl:2 row_mask:0xf bank_mask:0xf
    v_mov_b32_dpp v70, v66 row_shl:2 row_mask:0xf bank_mask:0xf
    v_mov_b32_dpp v71, v67 row_shl:2 row_mask:0xf bank_mask:0xf
    v_cvt_pk_bf16_f32 v64, v64, v64
    v_and_b32 v64, 0xffff0000, v64
    v_cvt_pk_bf16_f32 v68, v68, v68
    v_and_b32 v68, 0xffff0000, v68
    v_mul_f32 v72, v64, v64
    v_mov_b32 v84, 0x3d372713
    v_fma_f32 v72, v72, v84, 1.0
    v_mul_f32 v72, v72, v64
    v_mul_f32 v72, 0xc0135761, v72
    v_exp_f32 v72, v72
    s_nop 0
    v_add_f32 v72, 1.0, v72
    v_rcp_f32 v72, v72
    s_nop 0
    v_mul_f32 v72, v72, v64
    v_cvt_pk_bf16_f32 v72, v72, v72
    v_and_b32 v72, 0xffff0000, v72
    v_mul_f32 v72, v72, v68
    v_cvt_pk_bf16_f32 v72, v72, v72
    v_and_b32 v72, 0xffff0000, v72
    v_cvt_pk_bf16_f32 v65, v65, v65
    v_and_b32 v65, 0xffff0000, v65
    v_cvt_pk_bf16_f32 v69, v69, v69
    v_and_b32 v69, 0xffff0000, v69
    v_mul_f32 v73, v65, v65
    v_mov_b32 v84, 0x3d372713
    v_fma_f32 v73, v73, v84, 1.0
    v_mul_f32 v73, v73, v65
    v_mul_f32 v73, 0xc0135761, v73
    v_exp_f32 v73, v73
    s_nop 0
    v_add_f32 v73, 1.0, v73
    v_rcp_f32 v73, v73
    s_nop 0
    v_mul_f32 v73, v73, v65
    v_cvt_pk_bf16_f32 v73, v73, v73
    v_and_b32 v73, 0xffff0000, v73
    v_mul_f32 v73, v73, v69
    v_cvt_pk_bf16_f32 v73, v73, v73
    v_and_b32 v73, 0xffff0000, v73
    v_cvt_pk_bf16_f32 v66, v66, v66
    v_and_b32 v66, 0xffff0000, v66
    v_cvt_pk_bf16_f32 v70, v70, v70
    v_and_b32 v70, 0xffff0000, v70
    v_mul_f32 v74, v66, v66
    v_mov_b32 v84, 0x3d372713
    v_fma_f32 v74, v74, v84, 1.0
    v_mul_f32 v74, v74, v66
    v_mul_f32 v74, 0xc0135761, v74
    v_exp_f32 v74, v74
    s_nop 0
    v_add_f32 v74, 1.0, v74
    v_rcp_f32 v74, v74
    s_nop 0
    v_mul_f32 v74, v74, v66
    v_cvt_pk_bf16_f32 v74, v74, v74
    v_and_b32 v74, 0xffff0000, v74
    v_mul_f32 v74, v74, v70
    v_cvt_pk_bf16_f32 v74, v74, v74
    v_and_b32 v74, 0xffff0000, v74
    v_cvt_pk_bf16_f32 v67, v67, v67
    v_and_b32 v67, 0xffff0000, v67
    v_cvt_pk_bf16_f32 v71, v71, v71
    v_and_b32 v71, 0xffff0000, v71
    v_mul_f32 v75, v67, v67
    v_mov_b32 v84, 0x3d372713
    v_fma_f32 v75, v75, v84, 1.0
    v_mul_f32 v75, v75, v67
    v_mul_f32 v75, 0xc0135761, v75
    v_exp_f32 v75, v75
    s_nop 0
    v_add_f32 v75, 1.0, v75
    v_rcp_f32 v75, v75
    s_nop 0
    v_mul_f32 v75, v75, v67
    v_cvt_pk_bf16_f32 v75, v75, v75
    v_and_b32 v75, 0xffff0000, v75
    v_mul_f32 v75, v75, v71
    v_cvt_pk_bf16_f32 v75, v75, v75
    v_and_b32 v75, 0xffff0000, v75
    s_nop 0
    v_readlane_b32 s70, v72, 0
    v_readlane_b32 s71, v73, 0
    v_readlane_b32 s72, v74, 0
    v_readlane_b32 s73, v75, 0
    v_readlane_b32 s74, v72, 1
    v_readlane_b32 s75, v73, 1
    v_readlane_b32 s76, v74, 1
    v_readlane_b32 s77, v75, 1
    s_nop 1
    v_lshlrev_b32 v88, 16, v192
    v_and_b32 v89, 0xffff0000, v192
    v_mul_f32 v64, s70, v88
    v_mul_f32 v65, s70, v89
    v_lshlrev_b32 v88, 16, v193
    v_and_b32 v89, 0xffff0000, v193
    v_mul_f32 v66, s70, v88
    v_mul_f32 v67, s70, v89
    v_lshlrev_b32 v88, 16, v194
    v_and_b32 v89, 0xffff0000, v194
    v_mul_f32 v68, s70, v88
    v_mul_f32 v69, s70, v89
    v_lshlrev_b32 v88, 16, v195
    v_and_b32 v89, 0xffff0000, v195
    v_mul_f32 v70, s70, v88
    v_mul_f32 v71, s70, v89
    v_lshlrev_b32 v88, 16, v196
    v_and_b32 v89, 0xffff0000, v196
    v_fmac_f32 v64, s71, v88
    v_fmac_f32 v65, s71, v89
    v_lshlrev_b32 v88, 16, v197
    v_and_b32 v89, 0xffff0000, v197
    v_fmac_f32 v66, s71, v88
    v_fmac_f32 v67, s71, v89
    v_lshlrev_b32 v88, 16, v198
    v_and_b32 v89, 0xffff0000, v198
    v_fmac_f32 v68, s71, v88
    v_fmac_f32 v69, s71, v89
    v_lshlrev_b32 v88, 16, v199
    v_and_b32 v89, 0xffff0000, v199
    v_fmac_f32 v70, s71, v88
    v_fmac_f32 v71, s71, v89
    v_lshlrev_b32 v88, 16, v200
    v_and_b32 v89, 0xffff0000, v200
    v_fmac_f32 v64, s72, v88
    v_fmac_f32 v65, s72, v89
    v_lshlrev_b32 v88, 16, v201
    v_and_b32 v89, 0xffff0000, v201
    v_fmac_f32 v66, s72, v88
    v_fmac_f32 v67, s72, v89
    v_lshlrev_b32 v88, 16, v202
    v_and_b32 v89, 0xffff0000, v202
    v_fmac_f32 v68, s72, v88
    v_fmac_f32 v69, s72, v89
    v_lshlrev_b32 v88, 16, v203
    v_and_b32 v89, 0xffff0000, v203
    v_fmac_f32 v70, s72, v88
    v_fmac_f32 v71, s72, v89
    v_lshlrev_b32 v88, 16, v204
    v_and_b32 v89, 0xffff0000, v204
    v_fmac_f32 v64, s73, v88
    v_fmac_f32 v65, s73, v89
    v_lshlrev_b32 v88, 16, v205
    v_and_b32 v89, 0xffff0000, v205
    v_fmac_f32 v66, s73, v88
    v_fmac_f32 v67, s73, v89
    v_lshlrev_b32 v88, 16, v206
    v_and_b32 v89, 0xffff0000, v206
    v_fmac_f32 v68, s73, v88
    v_fmac_f32 v69, s73, v89
    v_lshlrev_b32 v88, 16, v207
    v_and_b32 v89, 0xffff0000, v207
    v_fmac_f32 v70, s73, v88
    v_fmac_f32 v71, s73, v89
    v_lshlrev_b32 v88, 16, v208
    v_and_b32 v89, 0xffff0000, v208
    v_fmac_f32 v64, s74, v88
    v_fmac_f32 v65, s74, v89
    v_lshlrev_b32 v88, 16, v209
    v_and_b32 v89, 0xffff0000, v209
    v_fmac_f32 v66, s74, v88
    v_fmac_f32 v67, s74, v89
    v_lshlrev_b32 v88, 16, v210
    v_and_b32 v89, 0xffff0000, v210
    v_fmac_f32 v68, s74, v88
    v_fmac_f32 v69, s74, v89
    v_lshlrev_b32 v88, 16, v211
    v_and_b32 v89, 0xffff0000, v211
    v_fmac_f32 v70, s74, v88
    v_fmac_f32 v71, s74, v89
    v_lshlrev_b32 v88, 16, v212
    v_and_b32 v89, 0xffff0000, v212
    v_fmac_f32 v64, s75, v88
    v_fmac_f32 v65, s75, v89
    v_lshlrev_b32 v88, 16, v213
    v_and_b32 v89, 0xffff0000, v213
    v_fmac_f32 v66, s75, v88
    v_fmac_f32 v67, s75, v89
    v_lshlrev_b32 v88, 16, v214
    v_and_b32 v89, 0xffff0000, v214
    v_fmac_f32 v68, s75, v88
    v_fmac_f32 v69, s75, v89
    v_lshlrev_b32 v88, 16, v215
    v_and_b32 v89, 0xffff0000, v215
    v_fmac_f32 v70, s75, v88
    v_fmac_f32 v71, s75, v89
    v_lshlrev_b32 v88, 16, v216
    v_and_b32 v89, 0xffff0000, v216
    v_fmac_f32 v64, s76, v88
    v_fmac_f32 v65, s76, v89
    v_lshlrev_b32 v88, 16, v217
    v_and_b32 v89, 0xffff0000, v217
    v_fmac_f32 v66, s76, v88
    v_fmac_f32 v67, s76, v89
    v_lshlrev_b32 v88, 16, v218
    v_and_b32 v89, 0xffff0000, v218
    v_fmac_f32 v68, s76, v88
    v_fmac_f32 v69, s76, v89
    v_lshlrev_b32 v88, 16, v219
    v_and_b32 v89, 0xffff0000, v219
    v_fmac_f32 v70, s76, v88
    v_fmac_f32 v71, s76, v89
    v_lshlrev_b32 v88, 16, v220
    v_and_b32 v89, 0xffff0000, v220
    v_fmac_f32 v64, s77, v88
    v_fmac_f32 v65, s77, v89
    v_lshlrev_b32 v88, 16, v221
    v_and_b32 v89, 0xffff0000, v221
    v_fmac_f32 v66, s77, v88
    v_fmac_f32 v67, s77, v89
    v_lshlrev_b32 v88, 16, v222
    v_and_b32 v89, 0xffff0000, v222
    v_fmac_f32 v68, s77, v88
    v_fmac_f32 v69, s77, v89
    v_lshlrev_b32 v88, 16, v223
    v_and_b32 v89, 0xffff0000, v223
    v_fmac_f32 v70, s77, v88
    v_fmac_f32 v71, s77, v89
    v_mov_b32 v55, 0xfffff000
    v_and_or_b32 v64, v64, v55, s60
    v_and_or_b32 v65, v65, v55, s61
    v_and_or_b32 v66, v66, v55, s62
    v_and_or_b32 v67, v67, v55, s63
    v_and_or_b32 v68, v68, v55, s60
    v_and_or_b32 v69, v69, v55, s61
    v_and_or_b32 v70, v70, v55, s62
    v_and_or_b32 v71, v71, v55, s63
    s_lshl_b32 s41, s59, 11
    v_add_u32 v80, s41, v3
    global_store_dwordx4 v80, v[64:67], s[52:53] sc1
    global_store_dwordx4 v80, v[68:71], s[52:53] offset:1024 sc1
    s_branch L_tailsetup
L_cons:
    s_mov_b32 s75, 0
    v_mov_b32 v15, 1
    s_mov_b64 exec, 1
    ds_add_rtn_u32 v46, v14, v15 offset:4
    s_mov_b64 exec, -1
L_main:
    s_waitcnt lgkmcnt(0)
    v_readfirstlane_b32 s70, v46
    s_mov_b32 s45, 1000000
    s_lshl_b32 s72, s70, 1
L_c_wait:
    ds_read_b128 v[56:59], v14
    s_waitcnt lgkmcnt(0)
    v_cmp_lt_u32 vcc, s72, v56
    s_cbranch_vccnz L_c_go
    v_readfirstlane_b32 s71, v59
    s_sub_u32 s71, s71, 1
    s_cmp_gt_u32 s70, s71
    s_cbranch_scc1 L_done
    s_sleep 1
    s_sub_u32 s45, s45, 1
    s_cmp_lg_u32 s45, 0
    s_cbranch_scc1 L_c_wait
    s_branch L_done
L_c_go:
    s_and_b32 s73, s70, 7
    s_lshl_b32 s71, s73, 14
    s_add_u32 s71, s71, 24576
    v_add_u32 v48, s71, v3
    ds_read_b128 v[96:99], v48 offset:0
    ds_read_b128 v[100:103], v48 offset:1024
    ds_read_b128 v[104:107], v48 offset:2048
    ds_read_b128 v[108:111], v48 offset:3072
    ds_read_b128 v[112:115], v48 offset:4096
    ds_read_b128 v[116:119], v48 offset:5120
    ds_read_b128 v[120:123], v48 offset:6144
    ds_read_b128 v[124:127], v48 offset:7168
    s_mov_b64 exec, 1
    ds_add_rtn_u32 v46, v14, v15 offset:4
    s_mov_b64 exec, -1
    s_lshl_b32 s73, s73, 2
    s_add_u32 s73, s73, 3600
    v_mov_b32 v49, s73
    s_add_u32 s74, s70, 1
    s_add_u32 s72, s72, 1
    s_cmp_lg_u32 s75, 0
    s_cbranch_scc1 L_haveq
    s_mov_b32 s45, 1000000
L_v_waitf:
    ds_read_b32 v47, v14
    s_waitcnt lgkmcnt(0)
    v_cmp_lt_u32 vcc, s72, v47
    s_cbranch_vccnz L_v_gof
    s_sub_u32 s45, s45, 1
    s_cmp_lg_u32 s45, 0
    s_cbranch_scc1 L_v_waitf
L_v_gof:
    ds_read_b128 v[128:131], v48 offset:8192
    ds_read_b128 v[132:135], v48 offset:9216
    ds_read_b128 v[136:139], v48 offset:10240
    ds_read_b128 v[140:143], v48 offset:11264
    ds_read_b128 v[144:147], v48 offset:12288
    ds_read_b128 v[148:151], v48 offset:13312
    ds_read_b128 v[152:155], v48 offset:14336
    ds_read_b128 v[156:159], v48 offset:15360
    v_mov_b32 v47, s74
    s_waitcnt lgkmcnt(0)
    ds_write_b32 v49, v47
    s_mov_b32 s45, 1000000
L_qwait:
    ds_read_b32 v47, v14 offset:8
    s_waitcnt lgkmcnt(0)
    v_cmp_ne_u32 vcc, 0, v47
    s_cbranch_vccnz L_qready
    s_sleep 2
    s_sub_u32 s45, s45, 1
    s_cmp_lg_u32 s45, 0
    s_cbranch_scc1 L_qwait
L_qready:
    ds_read_b128 v[4:7], v3 offset:1024
L_haveq:
    s_waitcnt lgkmcnt(0)
    v_mfma_f32_16x16x32_bf16 v[64:67], v[96:99], v[4:7], 0
    v_mfma_f32_16x16x32_bf16 v[68:71], v[100:103], v[4:7], 0
    v_mfma_f32_16x16x32_bf16 v[72:75], v[104:107], v[4:7], 0
    v_mfma_f32_16x16x32_bf16 v[76:79], v[108:111], v[4:7], 0
    v_mfma_f32_16x16x32_bf16 v[80:83], v[112:115], v[4:7], 0
    v_mfma_f32_16x16x32_bf16 v[84:87], v[116:119], v[4:7], 0
    v_mfma_f32_16x16x32_bf16 v[88:91], v[120:123], v[4:7], 0
    v_mfma_f32_16x16x32_bf16 v[92:95], v[124:127], v[4:7], 0
    s_nop 7
    v_mov_b32_dpp v34, v64 quad_perm:[0,0,0,0] row_mask:0xf bank_mask:0xf
    v_add_f32_dpp v34, v65, v34 quad_perm:[1,1,1,1] row_mask:0xf bank_mask:0xf
    v_add_f32_dpp v34, v66, v34 quad_perm:[2,2,2,2] row_mask:0xf bank_mask:0xf
    v_add_f32_dpp v34, v67, v34 quad_perm:[3,3,3,3] row_mask:0xf bank_mask:0xf
    v_mov_b32_dpp v35, v68 quad_perm:[0,0,0,0] row_mask:0xf bank_mask:0xf
    v_add_f32_dpp v35, v69, v35 quad_perm:[1,1,1,1] row_mask:0xf bank_mask:0xf
    v_add_f32_dpp v35, v70, v35 quad_perm:[2,2,2,2] row_mask:0xf bank_mask:0xf
    v_add_f32_dpp v35, v71, v35 quad_perm:[3,3,3,3] row_mask:0xf bank_mask:0xf
    v_mov_b32_dpp v36, v72 quad_perm:[0,0,0,0] row_mask:0xf bank_mask:0xf
    v_add_f32_dpp v36, v73, v36 quad_perm:[1,1,1,1] row_mask:0xf bank_mask:0xf
    v_add_f32_dpp v36, v74, v36 quad_perm:[2,2,2,2] row_mask:0xf bank_mask:0xf
    v_add_f32_dpp v36, v75, v36 quad_perm:[3,3,3,3] row_mask:0xf bank_mask:0xf
    v_mov_b32_dpp v37, v76 quad_perm:[0,0,0,0] row_mask:0xf bank_mask:0xf
    v_add_f32_dpp v37, v77, v37 quad_perm:[1,1,1,1] row_mask:0xf bank_mask:0xf
    v_add_f32_dpp v37, v78, v37 quad_perm:[2,2,2,2] row_mask:0xf bank_mask:0xf
    v_add_f32_dpp v37, v79, v37 quad_perm:[3,3,3,3] row_mask:0xf bank_mask:0xf
    v_mov_b32_dpp v38, v80 quad_perm:[0,0,0,0] row_mask:0xf bank_mask:0xf
    v_add_f32_dpp v38, v81, v38 quad_perm:[1,1,1,1] row_mask:0xf bank_mask:0xf
    v_add_f32_dpp v38, v82, v38 quad_perm:[2,2,2,2] row_mask:0xf bank_mask:0xf
    v_add_f32_dpp v38, v83, v38 quad_perm:[3,3,3,3] row_mask:0xf bank_mask:0xf
    v_mov_b32_dpp v39, v84 quad_perm:[0,0,0,0] row_mask:0xf bank_mask:0xf
    v_add_f32_dpp v39, v85, v39 quad_perm:[1,1,1,1] row_mask:0xf bank_mask:0xf
    v_add_f32_dpp v39, v86, v39 quad_perm:[2,2,2,2] row_mask:0xf bank_mask:0xf
    v_add_f32_dpp v39, v87, v39 quad_perm:[3,3,3,3] row_mask:0xf bank_mask:0xf
    v_mov_b32_dpp v40, v88 quad_perm:[0,0,0,0] row_mask:0xf bank_mask:0xf
    v_add_f32_dpp v40, v89, v40 quad_perm:[1,1,1,1] row_mask:0xf bank_mask:0xf
    v_add_f32_dpp v40, v90, v40 quad_perm:[2,2,2,2] row_mask:0xf bank_mask:0xf
    v_add_f32_dpp v40, v91, v40 quad_perm:[3,3,3,3] row_mask:0xf bank_mask:0xf
    v_mov_b32_dpp v41, v92 quad_perm:[0,0,0,0] row_mask:0xf bank_mask:0xf
    v_add_f32_dpp v41, v93, v41 quad_perm:[1,1,1,1] row_mask:0xf bank_mask:0xf
    v_add_f32_dpp v41, v94, v41 quad_perm:[2,2,2,2] row_mask:0xf bank_mask:0xf
    v_add_f32_dpp v41, v95, v41 quad_perm:[3,3,3,3] row_mask:0xf bank_mask:0xf
    v_cvt_pk_bf16_f32 v50, v34, v35
    v_cvt_pk_bf16_f32 v51, v36, v37
    v_cvt_pk_bf16_f32 v52, v38, v39
    v_cvt_pk_bf16_f32 v53, v40, v41
    v_lshlrev_b32 v34, 16, v50
    v_and_b32 v35, 0xffff0000, v50
    v_lshlrev_b32 v36, 16, v51
    v_and_b32 v37, 0xffff0000, v51
    v_lshlrev_b32 v38, 16, v52
    v_and_b32 v39, 0xffff0000, v52
    v_lshlrev_b32 v40, 16, v53
    v_and_b32 v41, 0xffff0000, v53
    v_mul_f32 v34, s58, v34
    v_mul_f32 v35, s58, v35
    v_mul_f32 v36, s58, v36
    v_mul_f32 v37, s58, v37
    v_mul_f32 v38, s58, v38
    v_mul_f32 v39, s58, v39
    v_mul_f32 v40, s58, v40
    v_mul_f32 v41, s58, v41
    v_cvt_pk_bf16_f32 v50, v34, v35
    v_cvt_pk_bf16_f32 v51, v36, v37
    v_cvt_pk_bf16_f32 v52, v38, v39
    v_cvt_pk_bf16_f32 v53, v40, v41
    v_lshlrev_b32 v34, 16, v50
    v_and_b32 v35, 0xffff0000, v50
    v_lshlrev_b32 v36, 16, v51
    v_and_b32 v37, 0xffff0000, v51
    v_lshlrev_b32 v38, 16, v52
    v_and_b32 v39, 0xffff0000, v52
    v_lshlrev_b32 v40, 16, v53
    v_and_b32 v41, 0xffff0000, v53
    v_max3_f32 v50, v34, v35, v36
    v_max3_f32 v51, v37, v38, v39
    v_max3_f32 v50, v40, v41, v50
    v_max3_f32 v50, v50, v51, v10
    v_mov_b32 v51, v50
    s_nop 1
    v_permlane32_swap_b32 v51, v50
    v_max_f32 v50, v51, v50
    v_mov_b32 v51, v50
    s_nop 1
    v_permlane16_swap_b32 v51, v50
    v_max_f32 v50, v51, v50
    v_mul_f32 v12, s44, v50
    v_fma_f32 v13, v10, s44, -v12
    v_mov_b32 v10, v50
    v_exp_f32 v13, v13
    v_fma_f32 v34, v34, s44, -v12
    v_fma_f32 v35, v35, s44, -v12
    v_fma_f32 v36, v36, s44, -v12
    v_fma_f32 v37, v37, s44, -v12
    v_fma_f32 v38, v38, s44, -v12
    v_fma_f32 v39, v39, s44, -v12
    v_fma_f32 v40, v40, s44, -v12
    v_fma_f32 v41, v41, s44, -v12
    v_exp_f32 v34, v34
    v_exp_f32 v35, v35
    v_exp_f32 v36, v36
    v_exp_f32 v37, v37
    v_exp_f32 v38, v38
    v_exp_f32 v39, v39
    v_exp_f32 v40, v40
    v_exp_f32 v41, v41
    v_mul_f32 v16, v13, v16
    v_mul_f32 v17, v13, v17
    v_mul_f32 v18, v13, v18
    v_mul_f32 v19, v13, v19
    v_mul_f32 v20, v13, v20
    v_mul_f32 v21, v13, v21
    v_mul_f32 v22, v13, v22
    v_mul_f32 v23, v13, v23
    v_add_f32 v50, v34, v35
    v_add_f32 v51, v36, v37
    v_add_f32 v52, v38, v39
    v_add_f32 v53, v40, v41
    v_add_f32 v50, v50, v51
    v_add_f32 v52, v52, v53
    v_add_f32 v50, v50, v52
    v_fma_f32 v11, v11, v13, v50
    v_cvt_pk_bf16_f32 v34, v34, v34
    v_cvt_pk_bf16_f32 v35, v35, v35
    v_cvt_pk_bf16_f32 v36, v36, v36
    v_cvt_pk_bf16_f32 v37, v37, v37
    v_cvt_pk_bf16_f32 v38, v38, v38
    v_cvt_pk_bf16_f32 v39, v39, v39
    v_cvt_pk_bf16_f32 v40, v40, v40
    v_cvt_pk_bf16_f32 v41, v41, v41
    s_cmp_lg_u32 s75, 0
    s_mov_b32 s75, 1
    s_cbranch_scc0 L_pv
    s_mov_b32 s45, 1000000
L_v_wait:
    ds_read_b32 v47, v14
    s_waitcnt lgkmcnt(0)
    v_cmp_lt_u32 vcc, s72, v47
    s_cbranch_vccnz L_v_go
    s_sub_u32 s45, s45, 1
    s_cmp_lg_u32 s45, 0
    s_cbranch_scc1 L_v_wait
L_v_go:
    ds_read_b128 v[128:131], v48 offset:8192
    ds_read_b128 v[132:135], v48 offset:9216
    ds_read_b128 v[136:139], v48 offset:10240
    ds_read_b128 v[140:143], v48 offset:11264
    ds_read_b128 v[144:147], v48 offset:12288
    ds_read_b128 v[148:151], v48 offset:13312
    ds_read_b128 v[152:155], v48 offset:14336
    ds_read_b128 v[156:159], v48 offset:15360
    v_mov_b32 v47, s74
    s_waitcnt lgkmcnt(0)
    ds_write_b32 v49, v47
L_pv:
    v_and_b32 v26, v8, v34
    v_and_b32 v27, v9, v34
    v_and_b32 v30, v8, v35
    v_and_b32 v31, v9, v35
    v_mfma_f32_16x16x32_bf16 v[16:19], v[128:131], v[26:29], v[16:19]
    v_mfma_f32_16x16x32_bf16 v[20:23], v[128:131], v[24:27], v[20:23]
    v_and_b32 v26, v8, v36
    v_and_b32 v27, v9, v36
    v_mfma_f32_16x16x32_bf16 v[16:19], v[132:135], v[30:33], v[16:19]
    v_mfma_f32_16x16x32_bf16 v[20:23], v[132:135], v[28:31], v[20:23]
    v_and_b32 v30, v8, v37
    v_and_b32 v31, v9, v37
    v_mfma_f32_16x16x32_bf16 v[16:19], v[136:139], v[26:29], v[16:19]
    v_mfma_f32_16x16x32_bf16 v[20:23], v[136:139], v[24:27], v[20:23]
    v_and_b32 v26, v8, v38
    v_and_b32 v27, v9, v38
    v_mfma_f32_16x16x32_bf16 v[16:19], v[140:143], v[30:33], v[16:19]
    v_mfma_f32_16x16x32_bf16 v[20:23], v[140:143], v[28:31], v[20:23]
    v_and_b32 v30, v8, v39
    v_and_b32 v31, v9, v39
    v_mfma_f32_16x16x32_bf16 v[16:19], v[144:147], v[26:29], v[16:19]
    v_mfma_f32_16x16x32_bf16 v[20:23], v[144:147], v[24:27], v[20:23]
    v_and_b32 v26, v8, v40
    v_and_b32 v27, v9, v40
    v_mfma_f32_16x16x32_bf16 v[16:19], v[148:151], v[30:33], v[16:19]
    v_mfma_f32_16x16x32_bf16 v[20:23], v[148:151], v[28:31], v[20:23]
    v_and_b32 v30, v8, v41
    v_and_b32 v31, v9, v41
    v_mfma_f32_16x16x32_bf16 v[16:19], v[152:155], v[26:29], v[16:19]
    v_mfma_f32_16x16x32_bf16 v[20:23], v[152:155], v[24:27], v[20:23]
    s_nop 1
    v_mfma_f32_16x16x32_bf16 v[16:19], v[156:159], v[30:33], v[16:19]
    v_mfma_f32_16x16x32_bf16 v[20:23], v[156:159], v[28:31], v[20:23]
    s_branch L_main
L_done:
    s_sub_u32 s42, s29, 4
    s_cmp_lt_u32 s42, 2
    s_cbranch_scc0 L_nowo
    s_lshl_b32 s41, s42, 9
    v_lshlrev_b32 v50, 3, v1
    v_add_u32 v50, s41, v50
    s_add_u32 s46, s12, s64
    s_addc_u32 s47, s13, 0
    global_load_dwordx2 v[224:225], v50, s[46:47] offset:0
    global_load_dwordx2 v[240:241], v50, s[46:47] offset:1024
    s_add_u32 s46, s46, 4096
    s_addc_u32 s47, s47, 0
    global_load_dwordx2 v[232:233], v50, s[46:47] offset:0
    global_load_dwordx2 v[248:249], v50, s[46:47] offset:1024
    s_add_u32 s46, s46, 4096
    s_addc_u32 s47, s47, 0
    global_load_dwordx2 v[226:227], v50, s[46:47] offset:0
    global_load_dwordx2 v[242:243], v50, s[46:47] offset:1024
    s_add_u32 s46, s46, 4096
    s_addc_u32 s47, s47, 0
    global_load_dwordx2 v[234:235], v50, s[46:47] offset:0
    global_load_dwordx2 v[250:251], v50, s[46:47] offset:1024
    s_add_u32 s46, s46, 4096
    s_addc_u32 s47, s47, 0
    global_load_dwordx2 v[228:229], v50, s[46:47] offset:0
    global_load_dwordx2 v[244:245], v50, s[46:47] offset:1024
    s_add_u32 s46, s46, 4096
    s_addc_u32 s47, s47, 0
    global_load_dwordx2 v[236:237], v50, s[46:47] offset:0
    global_load_dwordx2 v[252:253], v50, s[46:47] offset:1024
    s_add_u32 s46, s46, 4096
    s_addc_u32 s47, s47, 0
    global_load_dwordx2 v[230:231], v50, s[46:47] offset:0
    global_load_dwordx2 v[246:247], v50, s[46:47] offset:1024
    s_add_u32 s46, s46, 4096
    s_addc_u32 s47, s47, 0
    global_load_dwordx2 v[238:239], v50, s[46:47] offset:0
    global_load_dwordx2 v[254:255], v50, s[46:47] offset:1024
L_nowo:
    v_mov_b32 v51, v11
    s_nop 1
    v_permlane32_swap_b32 v51, v11
    v_add_f32 v11, v51, v11
    v_mov_b32 v51, v11
    s_nop 1
    v_permlane16_swap_b32 v51, v11
    v_add_f32 v11, v51, v11
    s_lshl_b32 s41, s29, 11
    v_lshlrev_b32 v50, 5, v1
    v_add_u32 v50, s41, v50
    s_lshl_b32 s41, s29, 5
    v_lshlrev_b32 v52, 1, v1
    v_add_u32 v52, s41, v52
    v_and_b32 v53, 0x33, v1
    s_nop 4
    ds_write_b128 v50, v[16:19] offset:8192
    ds_write_b128 v50, v[20:23] offset:8208
    v_cmp_eq_u32 vcc, 0, v53
    s_and_saveexec_b64 s[42:43], vcc
    ds_write_b64 v52, v[10:11] offset:2048
    s_mov_b64 exec, s[42:43]
    v_mov_b32 v56, 1
    s_waitcnt lgkmcnt(0)
    s_mov_b64 exec, 1
    ds_add_u32 v14, v56 offset:48
    s_mov_b64 exec, -1
L_tailsetup:
    s_add_u32 s52, s26, 65536
    s_addc_u32 s53, s27, 0
    s_add_u32 s56, s26, 1310720
    s_addc_u32 s57, s27, 0
    v_mov_b32 v55, 0xfffff000
    s_sub_u32 s42, s29, 4
    s_cmp_lt_u32 s42, 2
    s_cbranch_scc0 L_t3entry
    s_lshl_b32 s41, s42, 10
    v_add_u32 v50, s41, v3
    v_bfe_u32 v51, v50, 7, 2
    v_lshlrev_b32 v51, 3, v51
    s_mov_b32 s45, 1000000
L_mwait:
    ds_read_b32 v56, v14 offset:48
    s_waitcnt lgkmcnt(0)
    v_cmp_eq_u32 vcc, 6, v56
    s_cbranch_vccnz L_mgo
    s_sub_u32 s45, s45, 1
    s_cmp_lg_u32 s45, 0
    s_cbranch_scc1 L_mwait
L_mgo:
    ds_read_b64 v[96:97], v51 offset:2080
    ds_read_b64 v[98:99], v51 offset:2144
    ds_read_b64 v[100:101], v51 offset:2176
    ds_read_b64 v[102:103], v51 offset:2208
    ds_read_b64 v[104:105], v51 offset:2240
    ds_read_b64 v[106:107], v51 offset:2272
    ds_read_b128 v[64:67], v50 offset:10240
    ds_read_b128 v[68:71], v50 offset:14336
    ds_read_b128 v[72:75], v50 offset:16384
    ds_read_b128 v[76:79], v50 offset:18432
    ds_read_b128 v[80:83], v50 offset:20480
    ds_read_b128 v[84:87], v50 offset:22528
    s_lshl_b32 s41, s30, 17
    s_lshl_b32 s43, s31, 12
    s_add_u32 s41, s41, s43
    v_add_u32 v53, s41, v50
    s_waitcnt lgkmcnt(6)
    v_max3_f32 v54, v96, v98, v100
    v_max3_f32 v52, v102, v104, v106
    v_max_f32 v54, v54, v52
    v_mul_f32 v52, s44, v54
    v_fma_f32 v96, v96, s44, -v52
    v_fma_f32 v98, v98, s44, -v52
    v_fma_f32 v100, v100, s44, -v52
    v_fma_f32 v102, v102, s44, -v52
    v_fma_f32 v104, v104, s44, -v52
    v_fma_f32 v106, v106, s44, -v52
    v_exp_f32 v96, v96
    v_exp_f32 v98, v98
    v_exp_f32 v100, v100
    v_exp_f32 v102, v102
    v_exp_f32 v104, v104
    v_exp_f32 v106, v106
    s_waitcnt lgkmcnt(0)
    v_mul_f32 v56, v96, v64
    v_mul_f32 v57, v96, v65
    v_mul_f32 v58, v96, v66
    v_mul_f32 v59, v96, v67
    v_mul_f32 v61, v96, v97
    v_fmac_f32 v56, v98, v68
    v_fmac_f32 v57, v98, v69
    v_fmac_f32 v58, v98, v70
    v_fmac_f32 v59, v98, v71
    v_fmac_f32 v61, v98, v99
    v_fmac_f32 v56, v100, v72
    v_fmac_f32 v57, v100, v73
    v_fmac_f32 v58, v100, v74
    v_fmac_f32 v59, v100, v75
    v_fmac_f32 v61, v100, v101
    v_fmac_f32 v56, v102, v76
    v_fmac_f32 v57, v102, v77
    v_fmac_f32 v58, v102, v78
    v_fmac_f32 v59, v102, v79
    v_fmac_f32 v61, v102, v103
    v_fmac_f32 v56, v104, v80
    v_fmac_f32 v57, v104, v81
    v_fmac_f32 v58, v104, v82
    v_fmac_f32 v59, v104, v83
    v_fmac_f32 v61, v104, v105
    v_fmac_f32 v56, v106, v84
    v_fmac_f32 v57, v106, v85
    v_fmac_f32 v58, v106, v86
    v_fmac_f32 v59, v106, v87
    v_fmac_f32 v61, v106, v107
    v_and_or_b32 v56, v56, v55, s60
    v_and_or_b32 v57, v57, v55, s61
    v_and_or_b32 v58, v58, v55, s62
    v_and_or_b32 v59, v59, v55, s63
    global_store_dwordx4 v53, v[56:59], s[52:53] sc1
    v_and_or_b32 v60, v54, v55, s60
    v_and_or_b32 v61, v61, v55, s61
    v_mov_b32 v62, s62
    v_mov_b32 v63, s63
    v_lshlrev_b32 v53, 1, v51
    v_add_u32 v53, s41, v53
    s_cmp_eq_u32 s29, 4
    s_cbranch_scc0 L_noml
    s_mov_b32 exec_lo, 0x01010101
    s_mov_b32 exec_hi, 0
    global_store_dwordx4 v53, v[60:63], s[52:53] offset:2048 sc1
    s_mov_b64 exec, -1
L_noml:
    v_lshrrev_b32 v50, 2, v1
    v_lshlrev_b32 v50, 12, v50
    s_lshl_b32 s41, s30, 17
    v_add_u32 v50, s41, v50
    s_bfe_u32 s43, s31, 0x20001
    s_lshl_b32 s43, s43, 4
    s_add_u32 s43, s43, 2048
    v_add_u32 v52, s43, v50
    v_and_b32 v51, 3, v1
    v_lshl_add_u32 v50, v51, 4, v50
    s_lshl_b32 s43, s31, 6
    v_add_u32 v50, s43, v50
    v_add_u32 v51, 0x10000, v50
    v_add_u32 v53, 0x10000, v52
    s_waitcnt vmcnt(1)
    v_lshlrev_b32 v160, 16, v224
    v_and_b32 v161, 0xffff0000, v224
    v_lshlrev_b32 v162, 16, v225
    v_and_b32 v163, 0xffff0000, v225
    v_lshlrev_b32 v164, 16, v226
    v_and_b32 v165, 0xffff0000, v226
    v_lshlrev_b32 v166, 16, v227
    v_and_b32 v167, 0xffff0000, v227
    v_lshlrev_b32 v168, 16, v228
    v_and_b32 v169, 0xffff0000, v228
    v_lshlrev_b32 v170, 16, v229
    v_and_b32 v171, 0xffff0000, v229
    v_lshlrev_b32 v172, 16, v230
    v_and_b32 v173, 0xffff0000, v230
    v_lshlrev_b32 v174, 16, v231
    v_and_b32 v175, 0xffff0000, v231
    v_lshlrev_b32 v176, 16, v232
    v_and_b32 v177, 0xffff0000, v232
    v_lshlrev_b32 v178, 16, v233
    v_and_b32 v179, 0xffff0000, v233
    v_lshlrev_b32 v180, 16, v234
    v_and_b32 v181, 0xffff0000, v234
    v_lshlrev_b32 v182, 16, v235
    v_and_b32 v183, 0xffff0000, v235
    v_lshlrev_b32 v184, 16, v236
    v_and_b32 v185, 0xffff0000, v236
    v_lshlrev_b32 v186, 16, v237
    v_and_b32 v187, 0xffff0000, v237
    v_lshlrev_b32 v188, 16, v238
    v_and_b32 v189, 0xffff0000, v238
    v_lshlrev_b32 v190, 16, v239
    v_and_b32 v191, 0xffff0000, v239
    v_lshlrev_b32 v192, 16, v240
    v_and_b32 v193, 0xffff0000, v240
    v_lshlrev_b32 v194, 16, v241
    v_and_b32 v195, 0xffff0000, v241
    v_lshlrev_b32 v196, 16, v242
    v_and_b32 v197, 0xffff0000, v242
    v_lshlrev_b32 v198, 16, v243
    v_and_b32 v199, 0xffff0000, v243
    v_lshlrev_b32 v200, 16, v244
    v_and_b32 v201, 0xffff0000, v244
    v_lshlrev_b32 v202, 16, v245
    v_and_b32 v203, 0xffff0000, v245
    v_lshlrev_b32 v204, 16, v246
    v_and_b32 v205, 0xffff0000, v246
    v_lshlrev_b32 v206, 16, v247
    v_and_b32 v207, 0xffff0000, v247
    v_lshlrev_b32 v208, 16, v248
    v_and_b32 v209, 0xffff0000, v248
    v_lshlrev_b32 v210, 16, v249
    v_and_b32 v211, 0xffff0000, v249
    v_lshlrev_b32 v212, 16, v250
    v_and_b32 v213, 0xffff0000, v250
    v_lshlrev_b32 v214, 16, v251
    v_and_b32 v215, 0xffff0000, v251
    v_lshlrev_b32 v216, 16, v252
    v_and_b32 v217, 0xffff0000, v252
    v_lshlrev_b32 v218, 16, v253
    v_and_b32 v219, 0xffff0000, v253
    v_lshlrev_b32 v220, 16, v254
    v_and_b32 v221, 0xffff0000, v254
    v_lshlrev_b32 v222, 16, v255
    v_and_b32 v223, 0xffff0000, v255
    s_sleep 12
    global_load_dwordx4 v[64:67], v50, s[52:53] sc1
    global_load_dwordx4 v[68:71], v51, s[52:53] sc1
    global_load_dwordx4 v[72:75], v52, s[52:53] sc1
    global_load_dwordx4 v[76:79], v53, s[52:53] sc1
    s_mov_b32 s45, 200000
L_t2poll:
    s_waitcnt vmcnt(0)
    v_xor_b32 v112, s60, v64
    v_xor_b32 v113, s61, v65
    v_xor_b32 v114, s62, v66
    v_xor_b32 v115, s63, v67
    v_xor_b32 v116, s60, v68
    v_xor_b32 v117, s61, v69
    v_xor_b32 v118, s62, v70
    v_xor_b32 v119, s63, v71
    v_xor_b32 v120, s60, v72
    v_xor_b32 v121, s61, v73
    v_xor_b32 v122, s62, v74
    v_xor_b32 v123, s63, v75
    v_xor_b32 v124, s60, v76
    v_xor_b32 v125, s61, v77
    v_xor_b32 v126, s62, v78
    v_xor_b32 v127, s63, v79
    v_or3_b32 v54, v112, v113, v114
    v_or3_b32 v54, v54, v115, v116
    v_or3_b32 v54, v54, v117, v118
    v_or3_b32 v54, v54, v119, v120
    v_or3_b32 v54, v54, v121, v122
    v_or3_b32 v54, v54, v123, v124
    v_or3_b32 v54, v54, v125, v126
    v_or_b32 v54, v54, v127
    v_and_b32 v54, 0xfff, v54
    v_cmp_ne_u32 vcc, 0, v54
    s_cbranch_vccz L_t2got
    global_load_dwordx4 v[64:67], v50, s[52:53] sc1
    global_load_dwordx4 v[68:71], v51, s[52:53] sc1
    global_load_dwordx4 v[72:75], v52, s[52:53] sc1
    global_load_dwordx4 v[76:79], v53, s[52:53] sc1
    s_sub_u32 s45, s45, 1
    s_cmp_lg_u32 s45, 0
    s_cbranch_scc1 L_t2poll
L_t2got:
    v_max_f32 v54, v120, v124
    s_nop 1
    v_max_f32_dpp v54, v54, v54 row_ror:4 row_mask:0xf bank_mask:0xf
    s_nop 1
    v_max_f32_dpp v54, v54, v54 row_ror:8 row_mask:0xf bank_mask:0xf
    v_mov_b32 v56, v54
    s_nop 1
    v_permlane16_swap_b32 v56, v54
    v_max_f32 v54, v56, v54
    v_mov_b32 v56, v54
    s_nop 1
    v_permlane32_swap_b32 v56, v54
    v_max_f32 v54, v56, v54
    v_mul_f32 v56, s44, v54
    v_fma_f32 v120, v120, s44, -v56
    v_fma_f32 v124, v124, s44, -v56
    v_exp_f32 v120, v120
    v_exp_f32 v124, v124
    s_nop 0
    v_mul_f32 v112, v120, v112
    v_mul_f32 v113, v120, v113
    v_mul_f32 v114, v120, v114
    v_mul_f32 v115, v120, v115
    v_mul_f32 v121, v120, v121
    v_fmac_f32 v112, v124, v116
    v_fmac_f32 v113, v124, v117
    v_fmac_f32 v114, v124, v118
    v_fmac_f32 v115, v124, v119
    v_fmac_f32 v121, v124, v125
    v_mov_b32 v116, v121
    s_nop 0
    v_add_f32_dpp v112, v112, v112 row_ror:4 row_mask:0xf bank_mask:0xf
    v_add_f32_dpp v113, v113, v113 row_ror:4 row_mask:0xf bank_mask:0xf
    v_add_f32_dpp v114, v114, v114 row_ror:4 row_mask:0xf bank_mask:0xf
    v_add_f32_dpp v115, v115, v115 row_ror:4 row_mask:0xf bank_mask:0xf
    v_add_f32_dpp v116, v116, v116 row_ror:4 row_mask:0xf bank_mask:0xf
    s_nop 0
    v_add_f32_dpp v112, v112, v112 row_ror:8 row_mask:0xf bank_mask:0xf
    v_add_f32_dpp v113, v113, v113 row_ror:8 row_mask:0xf bank_mask:0xf
    v_add_f32_dpp v114, v114, v114 row_ror:8 row_mask:0xf bank_mask:0xf
    v_add_f32_dpp v115, v115, v115 row_ror:8 row_mask:0xf bank_mask:0xf
    v_add_f32_dpp v116, v116, v116 row_ror:8 row_mask:0xf bank_mask:0xf
    v_mov_b32 v120, v112
    v_mov_b32 v121, v113
    v_mov_b32 v122, v114
    v_mov_b32 v123, v115
    v_mov_b32 v124, v116
    s_nop 0
    v_permlane16_swap_b32 v120, v112
    v_permlane16_swap_b32 v121, v113
    v_permlane16_swap_b32 v122, v114
    v_permlane16_swap_b32 v123, v115
    v_permlane16_swap_b32 v124, v116
    v_add_f32 v112, v112, v120
    v_add_f32 v113, v113, v121
    v_add_f32 v114, v114, v122
    v_add_f32 v115, v115, v123
    v_add_f32 v116, v116, v124
    v_mov_b32 v120, v112
    v_mov_b32 v121, v113
    v_mov_b32 v122, v114
    v_mov_b32 v123, v115
    v_mov_b32 v124, v116
    s_nop 0
    v_permlane32_swap_b32 v120, v112
    v_permlane32_swap_b32 v121, v113
    v_permlane32_swap_b32 v122, v114
    v_permlane32_swap_b32 v123, v115
    v_permlane32_swap_b32 v124, v116
    v_add_f32 v112, v112, v120
    v_add_f32 v113, v113, v121
    v_add_f32 v114, v114, v122
    v_add_f32 v115, v115, v123
    v_add_f32 v116, v116, v124
    v_rcp_f32 v116, v116
    s_nop 0
    v_mul_f32 v112, v112, v116
    v_mul_f32 v113, v113, v116
    v_mul_f32 v114, v114, v116
    v_mul_f32 v115, v115, v116
    v_cvt_pk_bf16_f32 v112, v112, v112
    v_and_b32 v112, 0xffff0000, v112
    v_cvt_pk_bf16_f32 v113, v113, v113
    v_and_b32 v113, 0xffff0000, v113
    v_cvt_pk_bf16_f32 v114, v114, v114
    v_and_b32 v114, 0xffff0000, v114
    v_cvt_pk_bf16_f32 v115, v115, v115
    v_and_b32 v115, 0xffff0000, v115
    s_nop 0
    v_readlane_b32 s70, v112, 0
    v_readlane_b32 s71, v113, 0
    v_readlane_b32 s72, v114, 0
    v_readlane_b32 s73, v115, 0
    v_readlane_b32 s74, v112, 1
    v_readlane_b32 s75, v113, 1
    v_readlane_b32 s76, v114, 1
    v_readlane_b32 s77, v115, 1
    v_readlane_b32 s78, v112, 2
    v_readlane_b32 s79, v113, 2
    v_readlane_b32 s80, v114, 2
    v_readlane_b32 s81, v115, 2
    v_readlane_b32 s82, v112, 3
    v_readlane_b32 s83, v113, 3
    v_readlane_b32 s84, v114, 3
    v_readlane_b32 s85, v115, 3
    s_nop 1
    v_mul_f32 v56, s70, v160
    v_mul_f32 v57, s70, v161
    v_mul_f32 v58, s70, v162
    v_mul_f32 v59, s70, v163
    v_fmac_f32 v56, s71, v164
    v_fmac_f32 v57, s71, v165
    v_fmac_f32 v58, s71, v166
    v_fmac_f32 v59, s71, v167
    v_fmac_f32 v56, s72, v168
    v_fmac_f32 v57, s72, v169
    v_fmac_f32 v58, s72, v170
    v_fmac_f32 v59, s72, v171
    v_fmac_f32 v56, s73, v172
    v_fmac_f32 v57, s73, v173
    v_fmac_f32 v58, s73, v174
    v_fmac_f32 v59, s73, v175
    v_fmac_f32 v56, s74, v176
    v_fmac_f32 v57, s74, v177
    v_fmac_f32 v58, s74, v178
    v_fmac_f32 v59, s74, v179
    v_fmac_f32 v56, s75, v180
    v_fmac_f32 v57, s75, v181
    v_fmac_f32 v58, s75, v182
    v_fmac_f32 v59, s75, v183
    v_fmac_f32 v56, s76, v184
    v_fmac_f32 v57, s76, v185
    v_fmac_f32 v58, s76, v186
    v_fmac_f32 v59, s76, v187
    v_fmac_f32 v56, s77, v188
    v_fmac_f32 v57, s77, v189
    v_fmac_f32 v58, s77, v190
    v_fmac_f32 v59, s77, v191
    v_fmac_f32 v56, s78, v192
    v_fmac_f32 v57, s78, v193
    v_fmac_f32 v58, s78, v194
    v_fmac_f32 v59, s78, v195
    v_fmac_f32 v56, s79, v196
    v_fmac_f32 v57, s79, v197
    v_fmac_f32 v58, s79, v198
    v_fmac_f32 v59, s79, v199
    v_fmac_f32 v56, s80, v200
    v_fmac_f32 v57, s80, v201
    v_fmac_f32 v58, s80, v202
    v_fmac_f32 v59, s80, v203
    v_fmac_f32 v56, s81, v204
    v_fmac_f32 v57, s81, v205
    v_fmac_f32 v58, s81, v206
    v_fmac_f32 v59, s81, v207
    v_fmac_f32 v56, s82, v208
    v_fmac_f32 v57, s82, v209
    v_fmac_f32 v58, s82, v210
    v_fmac_f32 v59, s82, v211
    v_fmac_f32 v56, s83, v212
    v_fmac_f32 v57, s83, v213
    v_fmac_f32 v58, s83, v214
    v_fmac_f32 v59, s83, v215
    v_fmac_f32 v56, s84, v216
    v_fmac_f32 v57, s84, v217
    v_fmac_f32 v58, s84, v218
    v_fmac_f32 v59, s84, v219
    v_fmac_f32 v56, s85, v220
    v_fmac_f32 v57, s85, v221
    v_fmac_f32 v58, s85, v222
    v_fmac_f32 v59, s85, v223
    v_and_or_b32 v56, v56, v55, s60
    v_and_or_b32 v57, v57, v55, s61
    v_and_or_b32 v58, v58, v55, s62
    v_and_or_b32 v59, v59, v55, s63
    s_lshl_b32 s41, s2, 11
    s_lshl_b32 s43, s42, 10
    s_add_u32 s41, s41, s43
    v_add_u32 v53, s41, v3
    global_store_dwordx4 v53, v[56:59], s[56:57] sc1
    v_mov_b32 v60, 1
    s_mov_b64 exec, 1
    ds_add_u32 v14, v60 offset:8
    s_mov_b64 exec, -1
L_t3entry:
    s_cmp_ge_u32 s2, 32
    s_cbranch_scc1 L_fin
    s_add_u32 s52, s26, 1835008
    s_addc_u32 s53, s27, 0
    v_lshrrev_b32 v50, 2, v0
    v_and_b32 v51, 3, v0
    s_lshl_b32 s41, s2, 6
    v_lshlrev_b32 v51, 4, v51
    v_add_u32 v51, s41, v51
    v_lshl_add_u32 v52, v50, 11, v51
    v_add_u32 v53, 0x40000, v52
    v_add_u32 v55, 128, v50
    v_cmp_gt_u32 vcc, 224, v55
    v_min_u32 v55, 223, v55
    v_lshl_add_u32 v55, v55, 11, v51
    v_cndmask_b32 v49, 0, 1.0, vcc
    v_mov_b32 v51, v52
    s_lshl_b32 s41, s2, 5
    v_and_b32 v48, 15, v0
    v_lshlrev_b32 v48, 1, v48
    v_add_u32 v48, s41, v48
    global_load_ushort v47, v48, s[4:5]
    s_sub_u32 s42, s29, 4
    s_cmp_lt_u32 s42, 2
    s_cbranch_scc1 L_t3go
    s_mov_b32 s45, 1000000
L_t3wait:
    ds_read_b32 v56, v14 offset:8
    s_waitcnt lgkmcnt(0)
    v_cmp_eq_u32 vcc, 3, v56
    s_cbranch_vccnz L_t3go
    s_sleep 2
    s_sub_u32 s45, s45, 1
    s_cmp_lg_u32 s45, 0
    s_cbranch_scc1 L_t3wait
L_t3go:
    s_sleep 16
    global_load_dwordx4 v[64:67], v52, s[56:57] sc1
    global_load_dwordx4 v[68:71], v53, s[56:57] sc1
    global_load_dwordx4 v[72:75], v51, s[52:53] sc1
    global_load_dwordx4 v[76:79], v55, s[52:53] sc1
    s_mov_b32 s45, 200000
L_t3poll:
    s_waitcnt vmcnt(0)
    v_xor_b32 v112, s60, v64
    v_xor_b32 v113, s61, v65
    v_xor_b32 v114, s62, v66
    v_xor_b32 v115, s63, v67
    v_xor_b32 v116, s60, v68
    v_xor_b32 v117, s61, v69
    v_xor_b32 v118, s62, v70
    v_xor_b32 v119, s63, v71
    v_xor_b32 v120, s60, v72
    v_xor_b32 v121, s61, v73
    v_xor_b32 v122, s62, v74
    v_xor_b32 v123, s63, v75
    v_xor_b32 v124, s60, v76
    v_xor_b32 v125, s61, v77
    v_xor_b32 v126, s62, v78
    v_xor_b32 v127, s63, v79
    v_or3_b32 v54, v112, v113, v114
    v_or3_b32 v54, v54, v115, v116
    v_or3_b32 v54, v54, v117, v118
    v_or3_b32 v54, v54, v119, v120
    v_or3_b32 v54, v54, v121, v122
    v_or3_b32 v54, v54, v123, v124
    v_or3_b32 v54, v54, v125, v126
    v_or_b32 v54, v54, v127
    v_and_b32 v54, 0xfff, v54
    v_cmp_ne_u32 vcc, 0, v54
    s_cbranch_vccz L_t3got
    global_load_dwordx4 v[64:67], v52, s[56:57] sc1
    global_load_dwordx4 v[68:71], v53, s[56:57] sc1
    global_load_dwordx4 v[72:75], v51, s[52:53] sc1
    global_load_dwordx4 v[76:79], v55, s[52:53] sc1
    s_sub_u32 s45, s45, 1
    s_cmp_lg_u32 s45, 0
    s_cbranch_scc1 L_t3poll
L_t3got:
    v_add_f32 v112, v112, v116
    v_fma_f32 v116, v124, v49, v120
    v_add_f32 v113, v113, v117
    v_fma_f32 v117, v125, v49, v121
    v_add_f32 v114, v114, v118
    v_fma_f32 v118, v126, v49, v122
    v_add_f32 v115, v115, v119
    v_fma_f32 v119, v127, v49, v123
    s_nop 1
    v_permlane32_swap_b32 v112, v113
    v_permlane32_swap_b32 v114, v115
    v_permlane32_swap_b32 v116, v117
    v_permlane32_swap_b32 v118, v119
    v_add_f32 v112, v112, v113
    v_add_f32 v114, v114, v115
    v_add_f32 v116, v116, v117
    v_add_f32 v118, v118, v119
    s_nop 0
    v_permlane16_swap_b32 v112, v114
    v_permlane16_swap_b32 v116, v118
    v_add_f32 v112, v112, v114
    v_add_f32 v116, v116, v118
    s_nop 1
    v_add_f32_dpp v112, v112, v112 row_ror:4 row_mask:0xf bank_mask:0xf
    v_add_f32_dpp v116, v116, v116 row_ror:4 row_mask:0xf bank_mask:0xf
    s_nop 1
    v_add_f32_dpp v112, v112, v112 row_ror:8 row_mask:0xf bank_mask:0xf
    v_add_f32_dpp v116, v116, v116 row_ror:8 row_mask:0xf bank_mask:0xf
    v_lshrrev_b32 v56, 4, v1
    v_and_b32 v57, 1, v56
    v_lshrrev_b32 v56, 1, v56
    v_lshl_add_u32 v56, v57, 1, v56
    v_and_b32 v57, 3, v1
    v_lshl_add_u32 v56, v57, 2, v56
    v_lshlrev_b32 v56, 2, v56
    s_lshl_b32 s41, s29, 7
    v_add_u32 v56, s41, v56
    s_mov_b32 exec_lo, 0x000f000f
    s_mov_b32 exec_hi, 0x000f000f
    ds_write_b32 v56, v112 offset:2560
    ds_write_b32 v56, v116 offset:2624
    s_mov_b64 exec, -1
    s_waitcnt lgkmcnt(0)
    s_barrier
    s_cmp_eq_u32 s29, 0
    s_cbranch_scc0 L_fin
    v_and_b32 v57, 15, v1
    v_lshlrev_b32 v57, 2, v57
    ds_read_b32 v128, v57 offset:2560
    ds_read_b32 v129, v57 offset:2624
    ds_read_b32 v130, v57 offset:2688
    ds_read_b32 v131, v57 offset:2752
    ds_read_b32 v132, v57 offset:2816
    ds_read_b32 v133, v57 offset:2880
    ds_read_b32 v134, v57 offset:2944
    ds_read_b32 v135, v57 offset:3008
    ds_read_b32 v136, v57 offset:3072
    ds_read_b32 v137, v57 offset:3136
    ds_read_b32 v138, v57 offset:3200
    ds_read_b32 v139, v57 offset:3264
    ds_read_b32 v140, v57 offset:3328
    ds_read_b32 v141, v57 offset:3392
    ds_read_b32 v142, v57 offset:3456
    ds_read_b32 v143, v57 offset:3520
    s_waitcnt lgkmcnt(0)
    v_add_f32 v128, v128, v130
    v_add_f32 v129, v129, v131
    v_add_f32 v128, v128, v132
    v_add_f32 v129, v129, v133
    v_add_f32 v128, v128, v134
    v_add_f32 v129, v129, v135
    v_add_f32 v128, v128, v136
    v_add_f32 v129, v129, v137
    v_add_f32 v128, v128, v138
    v_add_f32 v129, v129, v139
    v_add_f32 v128, v128, v140
    v_add_f32 v129, v129, v141
    v_add_f32 v128, v128, v142
    v_add_f32 v129, v129, v143
    v_cvt_pk_bf16_f32 v128, v128, v128
    v_and_b32 v128, 0xffff0000, v128
    v_cvt_pk_bf16_f32 v129, v129, v129
    v_and_b32 v129, 0xffff0000, v129
    v_mul_f32 v130, 0xbfb8aa3b, v129
    v_exp_f32 v130, v130
    s_nop 0
    v_add_f32 v130, 1.0, v130
    v_rcp_f32 v130, v130
    s_nop 0
    v_mul_f32 v130, v130, v129
    v_cvt_pk_bf16_f32 v130, v130, v130
    v_and_b32 v130, 0xffff0000, v130
    v_mul_f32 v130, v130, v128
    v_cvt_pk_bf16_f32 v130, v130, v130
    v_and_b32 v130, 0xffff0000, v130
    v_lshlrev_b32 v47, 16, v47
    v_add_f32 v130, v130, v47
    v_cvt_pk_bf16_f32 v130, v130, v130
    s_mov_b64 exec, 0xffff
    global_store_short v48, v130, s[22:23] sc1
    s_cmp_eq_u32 s2, 0
    s_cbranch_scc0 L_fin
    s_mov_b64 exec, 1
    v_mov_b32 v57, 0
    v_mov_b32 v58, s68
    global_store_dword v57, v58, s[26:27] sc1
L_fin:
L_end:
    s_endpgm
.section .rodata,"a"
.p2align 6
.amdhsa_kernel recurrent_scan__gqa_block_cached__glu_gated_geglu__decode_kernel
  .amdhsa_next_free_vgpr 256
  .amdhsa_next_free_sgpr 102
  .amdhsa_accum_offset 256
  .amdhsa_group_segment_fixed_size 0
  .amdhsa_kernarg_size 96
  .amdhsa_user_sgpr_count 2
  .amdhsa_user_sgpr_kernarg_segment_ptr 1
  .amdhsa_system_sgpr_workgroup_id_x 1
.end_amdhsa_kernel
```
